```python
import torch

def _softmax(x, axis=-1):
    return torch.softmax(x, dim=axis)
def _gelu(x):
    return torch.nn.functional.gelu(x, approximate="tanh")
def _silu(x):
    return torch.nn.functional.silu(x)
def _sigmoid(x):
    return torch.sigmoid(x)
def _layernorm(x, axis=-1, eps=1e-5):
    m = x.mean(dim=axis, keepdim=True)
    v = x.var(dim=axis, keepdim=True, unbiased=False)
    return (x - m) / torch.sqrt(v + eps)
def _scatter_add(tgt, idx, src, axis=0):
    return tgt.clone().index_add_(axis, idx, src)
def _segment_sum(src, seg, n):
    out = torch.zeros((n,) + src.shape[1:], dtype=src.dtype)
    return out.index_add_(0, seg, src)
def _pad(x, pw):
    flat = tuple(v for pair in reversed(pw) for v in pair)
    return torch.nn.functional.pad(x, flat)

kernel_name = 'sequential_preLN__linear_attn_block__dense_activation_mish__prompt'

def setup_inputs():

    _w = (lambda a: (lambda t: t.to(torch.bfloat16) if t.is_floating_point() else t)(torch.as_tensor(a)))
    def _A_setup():
        B, S, D = 1, 2048, 512
        return {
            "x": _w((lambda *s: torch.randn(*s, dtype=torch.bfloat16) * 0.05)(B, S, D)),
            "wqkv": _w((lambda *s: torch.randn(*s, dtype=torch.bfloat16) * 0.05)(D, 3 * D)),
            "wo": _w((lambda *s: torch.randn(*s, dtype=torch.bfloat16) * 0.05)(D, D)),
        }
    _A_in = _A_setup()

    def _B_setup():
        B, S, D, F = 1, 2048, 512, 1792
        return {
            "x": _w((lambda *s: torch.randn(*s, dtype=torch.bfloat16) * 0.05)(B, S, D)),
            "w1": _w((lambda *s: torch.randn(*s, dtype=torch.bfloat16) * 0.8)(D, F) * (D ** -0.5)),
            "b1": _w((lambda *s: torch.randn(*s, dtype=torch.bfloat16) * 0.2)(F)),
            "w2": _w((lambda *s: torch.randn(*s, dtype=torch.bfloat16) * 0.1)(F, D) * (F ** -0.5)),
        }
    _B_in = _B_setup()

    return {
        "A_x": _A_in["x"],
        "A_wqkv": _A_in["wqkv"],
        "A_wo": _A_in["wo"],
        "B_x": _B_in["x"],
        "B_w1": _B_in["w1"],
        "B_b1": _B_in["b1"],
        "B_w2": _B_in["w2"],
    }

def reference(A_x, A_wqkv, A_wo, B_x, B_w1, B_b1, B_w2):
    def _A_ref(x, wqkv, wo):
        B, S, D = x.shape
        H = 32; Dh = D // H
        qkv = (lambda x, *d: x.permute(*d))((x @ wqkv).reshape(B, S, 3, H, Dh), 2, 0, 3, 1, 4)
        q, k, v = qkv[0], qkv[1], qkv[2]
        phi = lambda t: torch.where(t > 0, t + 1, torch.exp(t)) + 1e-6
        pq, pk = phi(q), phi(k)
        kv = torch.einsum("bhsd,bhse->bhde", pk, v)
        z = torch.einsum("bhsd->bhd", pk)
        num = torch.einsum("bhqd,bhde->bhqe", pq, kv)
        den = torch.einsum("bhqd,bhd->bhq", pq, z)[..., None] + 1e-6
        o = num / den
        return (lambda x, *d: x.permute(*d))(o, 0, 2, 1, 3).reshape(B, S, D) @ wo

    def _B_ref(x, w1, b1, w2):
        h = torch.einsum("bsd,df->bsf", x, w1) + b1
        sp = torch.log1p(torch.exp(-torch.abs(h))) + torch.where(h > 0, h, torch.zeros_like(h))
        act = h * torch.tanh(sp)
        return torch.einsum("bsf,fd->bsd", act, w2)

    x = A_x
    h = x + _A_ref(_layernorm(x, axis=-1), A_wqkv, A_wo)
    h2 = h + _B_ref(_layernorm(h, axis=-1), B_w1, B_b1, B_w2)
    return h2
```

```asm
; @launch grid=(256,1,1) block=(256,1,1) lds=163840
.amdgcn_target "amdgcn-amd-amdhsa--gfx950"
.text
.globl sequential_preLN__linear_attn_block__dense_activation_mish__prompt_kernel
.p2align 8
.type sequential_preLN__linear_attn_block__dense_activation_mish__prompt_kernel,@function
sequential_preLN__linear_attn_block__dense_activation_mish__prompt_kernel:
s_cmp_ge_u32 s2, 256
s_cbranch_scc1 L_done
s_load_dwordx2 s[8:9], s[0:1], 0
s_load_dwordx2 s[12:13], s[0:1], 8
s_load_dwordx2 s[16:17], s[0:1], 72
s_load_dwordx2 s[20:21], s[0:1], 64
s_load_dwordx2 s[24:25], s[0:1], 16
s_load_dwordx2 s[28:29], s[0:1], 32
s_load_dwordx2 s[32:33], s[0:1], 48
s_load_dwordx2 s[36:37], s[0:1], 40
s_load_dwordx2 s[40:41], s[0:1], 56
s_mov_b32 s10, 0x200000
s_mov_b32 s11, 0x20000
s_mov_b32 s14, 0x180000
s_mov_b32 s15, 0x20000
s_mov_b32 s18, 0x10000000
s_mov_b32 s19, 0x20000
s_mov_b32 s22, 0x100
s_mov_b32 s23, 0x20000
s_mov_b32 s26, 0x80000
s_mov_b32 s27, 0x20000
s_mov_b32 s30, 0x1c0000
s_mov_b32 s31, 0x20000
s_mov_b32 s34, 0x1c0000
s_mov_b32 s35, 0x20000
s_mov_b32 s38, 0xe00
s_mov_b32 s39, 0x20000
s_mov_b32 s42, 0x200000
s_mov_b32 s43, 0x20000
v_lshrrev_b32 v2, 6, v0
s_getpc_b64 s[96:97]
L_pc:
v_and_b32 v1, 3, v0
v_lshl_add_u32 v1, v2, 2, v1
s_lshr_b32 s7, s2, 3
s_lshl_b32 s7, s7, 11
v_lshl_add_u32 v1, v1, 7, s7
v_min_u32 v8, L_code_end-L_pc-4, v1
global_load_dword v8, v8, s[96:97]
s_bfe_u32 s4, s2, 0x20001
s_lshl_b32 s4, s4, 3
s_bfe_u32 s58, s2, 0x30003
s_add_u32 s4, s4, s58
s_and_b32 s5, s2, 1
s_lshl_b32 s5, s5, 2
s_lshr_b32 s44, s2, 6
s_add_u32 s5, s5, s44
s_lshl_b32 s44, s44, 1
s_add_u32 s58, s58, s44
v_lshrrev_b32 v1, 3, v0
v_readfirstlane_b32 s3, v2
v_lshl_add_u32 v1, v2, 3, v1
v_bfe_u32 v2, v0, 4, 2
v_and_b32 v3, 7, v0
v_xor_b32 v2, v2, v3
v_lshlrev_b32 v2, 4, v2
v_lshl_add_u32 v42, v1, 10, v2
s_lshl_b32 s7, s4, 16
v_add_u32 v42, s7, v42
v_xor_b32 v43, 64, v42
v_add_u32 v43, 7168, v43
v_bfe_u32 v2, v0, 4, 1
v_lshlrev_b32 v2, 1, v2
v_xor_b32 v2, v2, v3
v_lshlrev_b32 v4, 4, v2
v_mul_u32_u24 v44, 3072, v1
s_lshl_b32 s7, s5, 7
v_add3_u32 v44, v44, v4, s7
v_xor_b32 v45, 64, v44
v_add_u32 v45, 24576, v45
v_and_b32 v6, 63, v0
v_lshlrev_b32 v5, 4, v6
s_lshl_b32 s47, s3, 11
s_lshl_b32 s48, s3, 12
s_add_u32 s48, s48, 73728
s_add_u32 s7, s58, 0
s_and_b32 s7, s7, 7
s_lshl_b32 s45, s7, 7
s_mul_i32 s64, s7, 196608
s_add_u32 s7, s58, 1
s_and_b32 s7, s7, 7
s_mul_i32 s65, s7, 196608
s_add_u32 s7, s58, 2
s_and_b32 s7, s7, 7
s_mul_i32 s66, s7, 196608
s_add_u32 s7, s58, 3
s_and_b32 s7, s7, 7
s_mul_i32 s67, s7, 196608
s_add_u32 s7, s58, 4
s_and_b32 s7, s7, 7
s_mul_i32 s68, s7, 196608
s_add_u32 s7, s58, 5
s_and_b32 s7, s7, 7
s_mul_i32 s69, s7, 196608
s_add_u32 s7, s58, 6
s_and_b32 s7, s7, 7
s_mul_i32 s70, s7, 196608
s_add_u32 s7, s58, 7
s_and_b32 s7, s7, 7
s_mul_i32 s71, s7, 196608
v_mov_b32 v28, 0
v_mov_b32 v29, 0
v_mov_b32 v30, 0
v_mov_b32 v31, 0
s_cmp_ge_u32 s2, 16
s_cselect_b32 s55, 1, 0
s_xor_b32 s7, s3, 3
s_or_b32 s55, s55, s7
s_waitcnt lgkmcnt(0)
s_cmp_lg_u32 s55, 0
s_cbranch_scc1 L_nz
s_mul_i32 s7, s2, 8192
s_add_u32 s7, s7, 0x700000
buffer_store_dwordx4 v[28:31], v5, s[16:19], s7 offen offset:0 sc1
buffer_store_dwordx4 v[28:31], v5, s[16:19], s7 offen offset:1024 sc1
buffer_store_dwordx4 v[28:31], v5, s[16:19], s7 offen offset:2048 sc1
buffer_store_dwordx4 v[28:31], v5, s[16:19], s7 offen offset:3072 sc1
s_add_u32 s7, s7, 4096
buffer_store_dwordx4 v[28:31], v5, s[16:19], s7 offen offset:0 sc1
buffer_store_dwordx4 v[28:31], v5, s[16:19], s7 offen offset:1024 sc1
buffer_store_dwordx4 v[28:31], v5, s[16:19], s7 offen offset:2048 sc1
buffer_store_dwordx4 v[28:31], v5, s[16:19], s7 offen offset:3072 sc1
s_add_u32 s7, s7, 4096
L_nz:
s_add_u32 m0, s47, 57344
s_nop 0
buffer_load_dwordx4 v42, s[8:11], s45 offen lds
buffer_load_dwordx4 v43, s[8:11], s45 offen offset:1024 lds
s_add_u32 m0, s48, -1024
s_nop 0
buffer_load_dwordx4 v44, s[12:15], s64 offen offset:1024 lds
buffer_load_dwordx4 v44, s[12:15], s64 offen offset:2048 lds
s_add_u32 m0, s48, 1024
s_nop 0
buffer_load_dwordx4 v45, s[12:15], s64 offen offset:1024 lds
buffer_load_dwordx4 v45, s[12:15], s64 offen offset:2048 lds
s_add_u32 s45, s45, 128
s_and_b32 s45, s45, 0x3ff
s_add_u32 m0, s47, 65536
s_nop 0
buffer_load_dwordx4 v42, s[8:11], s45 offen lds
buffer_load_dwordx4 v43, s[8:11], s45 offen offset:1024 lds
s_bfe_u32 s6, s2, 0x20003
s_and_b32 s51, s2, 7
s_lshl_b32 s51, s51, 2
s_add_u32 s51, s51, s6
s_lshr_b32 s52, s2, 5
s_bfe_u32 s53, s2, 0x20001
s_lshl_b32 s53, s53, 2
s_add_u32 s53, s53, s6
s_and_b32 s54, s2, 1
s_lshl_b32 s54, s54, 3
s_add_u32 s54, s54, s52
s_mov_b32 s1, s3
s_lshl_b32 s7, s51, 2
s_add_u32 s7, s7, s3
s_lshl_b32 s7, s7, 3
s_add_u32 s7, s7, s52
s_lshl_b32 s7, s7, 7
s_add_u32 s7, s7, 0x600000
s_lshl_b32 s44, s53, 2
s_add_u32 s44, s44, s3
s_lshl_b32 s44, s44, 4
s_add_u32 s44, s44, s54
s_lshl_b32 s44, s44, 7
s_add_u32 s44, s44, 0x740000
v_add_u32 v1, s7, v5
v_lshrrev_b32 v2, 3, v6
v_lshl_add_u32 v2, v2, 17, s44
v_lshl_add_u32 v2, v3, 4, v2
v_cmp_gt_u32 vcc, 8, v6
s_nop 1
v_cndmask_b32 v1, v2, v1, vcc
s_mov_b64 exec, 0xffffff
buffer_store_dwordx4 v[28:31], v1, s[16:19], 0 offen sc1
s_mov_b64 exec, -1
v_min_u32 v39, 13, v6
v_lshlrev_b32 v39, 7, v39
v_min_u32 v46, 0x180, v39
s_lshl_b32 s7, s2, 2
s_add_u32 s7, s7, s3
s_mul_i32 s44, s7, 1792
v_add_u32 v39, s44, v39
s_lshl_b32 s44, s7, 9
v_add_u32 v46, s44, v46
s_lshr_b32 s7, s7, 1
s_lshl_b32 s7, s7, 11
v_add_u32 v47, s7, v46
buffer_load_dword v40, v46, s[24:27], 0 offen
v_lshlrev_b32 v6, 7, v6
v_mov_b32 v7, 1
v_mov_b32 v28, 0x3f803f80
v_mov_b32 v29, 0x3f803f80
v_mov_b32 v30, 0x3f803f80
v_mov_b32 v31, 0x3f803f80
v_bfe_u32 v48, v0, 4, 2
v_and_b32 v49, 15, v0
v_bfe_u32 v2, v0, 3, 3
v_lshl_add_u32 v60, v2, 10, v4
v_xor_b32 v4, 64, v60
v_add_u32 v61, 7168, v4
v_add_u32 v62, 14336, v60
v_add_u32 v63, 21504, v4
v_lshlrev_b32 v1, 1, v48
v_and_b32 v3, 7, v0
v_xor_b32 v1, v1, v3
v_lshlrev_b32 v1, 4, v1
v_lshl_add_u32 v10, v2, 10, v1
v_add_u32 v11, 7168, v10
v_add_u32 v12, 14336, v10
v_add_u32 v13, 21504, v10
v_lshrrev_b32 v1, 1, v49
v_xor_b32 v1, v1, v48
v_lshlrev_b32 v1, 4, v1
v_lshl_add_u32 v1, v49, 7, v1
s_add_u32 s7, s3, 0
s_and_b32 s59, s7, 3
s_lshl_b32 s7, s59, 11
s_add_u32 s7, s7, 57344
v_add_u32 v50, s7, v1
v_xor_b32 v51, 64, v50
s_add_u32 s7, s3, 1
s_and_b32 s60, s7, 3
s_lshl_b32 s7, s60, 11
s_add_u32 s7, s7, 57344
v_add_u32 v52, s7, v1
v_xor_b32 v53, 64, v52
s_add_u32 s7, s3, 2
s_and_b32 s61, s7, 3
s_lshl_b32 s7, s61, 11
s_add_u32 s7, s7, 57344
v_add_u32 v54, s7, v1
v_xor_b32 v55, 64, v54
s_add_u32 s7, s3, 3
s_and_b32 s62, s7, 3
s_lshl_b32 s7, s62, 11
s_add_u32 s7, s7, 57344
v_add_u32 v56, s7, v1
v_xor_b32 v57, 64, v56
v_lshrrev_b32 v1, 1, v48
v_lshlrev_b32 v1, 8, v1
v_lshl_add_u32 v1, v49, 4, v1
v_and_b32 v2, 1, v48
v_cmp_eq_u32 vcc, 1, v2
v_mov_b32 v2, s59
v_mov_b32 v3, s60
v_cndmask_b32 v2, v2, v3, vcc
v_lshl_add_u32 v68, v2, 14, v1
v_mov_b32 v2, s61
v_mov_b32 v3, s62
v_cndmask_b32 v2, v2, v3, vcc
v_lshl_add_u32 v69, v2, 14, v1
v_bfe_u32 v1, v0, 3, 2
v_lshlrev_b32 v1, 5, v1
v_and_b32 v2, 3, v0
v_lshl_add_u32 v1, v2, 3, v1
v_bfe_u32 v2, v0, 2, 2
v_lshl_add_u32 v1, v2, 7, v1
v_lshl_add_u32 v59, v48, 10, v1
v_add_u32 v64, 65536, v59
v_xor_b32 v65, 32, v64
v_xor_b32 v66, 64, v64
v_xor_b32 v67, 96, v64
s_lshl_b32 s7, s3, 5
v_xor_b32 v59, s7, v59
v_lshl_add_u32 v58, v48, 11, v1
v_xor_b32 v58, s7, v58
v_add_u32 v58, 73728, v58
v_lshl_add_u32 v14, v48, 9, v1
s_lshl_b32 s7, s3, 13
s_add_u32 s7, s7, 65536
v_add_u32 v14, s7, v14
v_xor_b32 v15, 32, v14
v_xor_b32 v16, 64, v14
v_xor_b32 v17, 96, v14
v_bfe_u32 v1, v0, 4, 1
v_lshlrev_b32 v1, 5, v1
v_bfe_u32 v2, v0, 5, 1
v_lshl_add_u32 v1, v2, 4, v1
v_lshl_add_u32 v9, v49, 10, v1
v_bfe_u32 v1, v0, 4, 1
v_lshlrev_b32 v1, 2, v1
v_sub_u32 v1, v49, v1
v_mov_b32 v2, 0x3f80
v_mov_b32 v3, 0x3f800000
v_cmp_eq_u32 vcc, 0, v1
s_nop 1
v_cndmask_b32 v72, 0, v2, vcc
v_cmp_eq_u32 vcc, 1, v1
s_nop 1
v_cndmask_b32 v72, v72, v3, vcc
v_cmp_eq_u32 vcc, 2, v1
s_nop 1
v_cndmask_b32 v73, 0, v2, vcc
v_cmp_eq_u32 vcc, 3, v1
s_nop 1
v_cndmask_b32 v73, v73, v3, vcc
v_cmp_eq_u32 vcc, 8, v1
s_nop 1
v_cndmask_b32 v74, 0, v2, vcc
v_cmp_eq_u32 vcc, 9, v1
s_nop 1
v_cndmask_b32 v74, v74, v3, vcc
v_cmp_eq_u32 vcc, 10, v1
s_nop 1
v_cndmask_b32 v75, 0, v2, vcc
v_cmp_eq_u32 vcc, 11, v1
s_nop 1
v_cndmask_b32 v75, v75, v3, vcc
v_and_b32 v76, 16, v0
v_bfe_u32 v2, v0, 5, 1
v_lshl_add_u32 v2, v2, 4, v49
v_lshl_add_u32 v77, v2, 7, v76
s_movk_i32 s7, 3584 - 224
v_add_u32 v1, 0, v0
v_mul_u32_u24 v2, 4682, v1
v_lshrrev_b32 v2, 16, v2
v_lshlrev_b32 v1, 4, v1
v_mad_u32_u24 v32, v2, s7, v1
v_add_u32 v1, 256, v0
v_mul_u32_u24 v2, 4682, v1
v_lshrrev_b32 v2, 16, v2
v_lshlrev_b32 v1, 4, v1
v_mad_u32_u24 v33, v2, s7, v1
v_add_u32 v1, 512, v0
v_mul_u32_u24 v2, 4682, v1
v_lshrrev_b32 v2, 16, v2
v_lshlrev_b32 v1, 4, v1
v_mad_u32_u24 v34, v2, s7, v1
v_add_u32 v1, 768, v0
v_mul_u32_u24 v2, 4682, v1
v_lshrrev_b32 v2, 16, v2
v_lshlrev_b32 v1, 4, v1
v_mad_u32_u24 v35, v2, s7, v1
v_add_u32 v1, 1024, v0
v_mul_u32_u24 v2, 4682, v1
v_lshrrev_b32 v2, 16, v2
v_lshlrev_b32 v1, 4, v1
v_mad_u32_u24 v36, v2, s7, v1
v_add_u32 v1, 1280, v0
v_mul_u32_u24 v2, 4682, v1
v_lshrrev_b32 v2, 16, v2
v_lshlrev_b32 v1, 4, v1
v_mad_u32_u24 v37, v2, s7, v1
v_add_u32 v1, 1536, v0
v_mul_u32_u24 v2, 4682, v1
v_lshrrev_b32 v2, 16, v2
v_lshlrev_b32 v1, 4, v1
v_mad_u32_u24 v38, v2, s7, v1
v_and_b32 v1, 3, v0
v_cmp_eq_u32 s[96:97], 1, v1
v_cmp_eq_u32 s[98:99], 2, v1
v_cmp_eq_u32 s[100:101], 3, v1
v_mov_b32 v78, 0x3f317218
v_mov_b32 v79, 0x3f800008
v_mov_b32 v80, 0x358637bd
v_mov_b32 v81, 0x358637bd
v_mov_b32 v82, 0x358637bd
v_mov_b32 v83, 0x358637bd
s_lshl_b32 s7, s3, 6
s_add_u32 s7, s7, 159744
v_lshl_add_u32 v85, v49, 2, s7
v_lshl_add_u32 v86, v48, 4, s7
v_lshlrev_b32 v87, 4, v5
v_lshrrev_b32 v87, 4, v87
s_lshl_b32 s56, s5, 2
s_add_u32 s56, s56, s3
s_lshl_b32 s7, s56, 5
s_add_u32 s7, s7, s4
s_lshl_b32 s57, s7, 9
s_lshl_b32 s58, s7, 7
s_add_u32 s58, s58, 0x700000
s_lshl_b32 s7, s52, 7
s_lshl_b32 s50, s6, 17
s_lshl_b32 s44, s3, 15
s_add_u32 s50, s50, s44
s_add_u32 s50, s50, s7
s_lshl_b32 s49, s51, 16
s_lshl_b32 s44, s1, 14
s_add_u32 s49, s49, s44
s_add_u32 s49, s49, s7
s_mul_i32 s46, s54, 224
s_add_u32 m0, s48, 23552
s_nop 0
buffer_load_dwordx4 v44, s[12:15], s65 offen offset:1024 lds
buffer_load_dwordx4 v44, s[12:15], s65 offen offset:2048 lds
s_add_u32 m0, s48, 25600
s_nop 0
buffer_load_dwordx4 v45, s[12:15], s65 offen offset:1024 lds
buffer_load_dwordx4 v45, s[12:15], s65 offen offset:2048 lds
s_add_u32 s45, s45, 128
s_and_b32 s45, s45, 0x3ff
s_add_u32 m0, s47, 90112
s_nop 0
buffer_load_dwordx4 v42, s[8:11], s45 offen lds
buffer_load_dwordx4 v43, s[8:11], s45 offen offset:1024 lds
s_waitcnt vmcnt(8)
s_barrier
ds_read_b64_tr_b16 v[160:161], v58 offset:0
ds_read_b64_tr_b16 v[162:163], v58 offset:512
ds_read_b64_tr_b16 v[164:165], v58 offset:1024
ds_read_b64_tr_b16 v[166:167], v58 offset:1536
ds_read_b128 a[0:3], v50 offset:0
ds_read_b128 a[64:67], v52 offset:0
ds_read_b128 a[128:131], v54 offset:0
ds_read_b128 a[192:195], v56 offset:0
ds_read_b128 a[4:7], v51 offset:0
ds_read_b128 a[8:11], v50 offset:8192
ds_read_b128 a[12:15], v51 offset:8192
s_add_u32 m0, s48, 48128
s_nop 0
buffer_load_dwordx4 v44, s[12:15], s66 offen offset:1024 lds
s_waitcnt lgkmcnt(7)
v_mfma_f32_16x16x32_bf16 v[184:187], v[28:31], v[160:163], 0
ds_read_b64_tr_b16 v[168:169], v58 offset:8192
ds_read_b64_tr_b16 v[170:171], v58 offset:8704
v_mfma_f32_16x16x32_bf16 v[188:191], v[28:31], v[164:167], 0
buffer_load_dwordx4 v44, s[12:15], s66 offen offset:2048 lds
s_waitcnt lgkmcnt(7)
v_mfma_f32_16x16x32_bf16 v[88:91], a[0:3], v[160:163], 0
ds_read_b64_tr_b16 v[172:173], v58 offset:9216
ds_read_b64_tr_b16 v[174:175], v58 offset:9728
v_mfma_f32_16x16x32_bf16 v[104:107], a[0:3], v[164:167], 0
s_add_u32 m0, s48, 50176
ds_read_b128 a[68:71], v53 offset:0
v_mfma_f32_16x16x32_bf16 v[92:95], a[64:67], v[160:163], 0
buffer_load_dwordx4 v45, s[12:15], s66 offen offset:1024 lds
v_mfma_f32_16x16x32_bf16 v[108:111], a[64:67], v[164:167], 0
ds_read_b128 a[132:135], v55 offset:0
ds_read_b128 a[196:199], v57 offset:0
s_waitcnt lgkmcnt(7)
v_mfma_f32_16x16x32_bf16 v[96:99], a[128:131], v[160:163], 0
ds_read_b128 a[72:75], v52 offset:8192
ds_read_b128 a[136:139], v54 offset:8192
v_mfma_f32_16x16x32_bf16 v[112:115], a[128:131], v[164:167], 0
buffer_load_dwordx4 v45, s[12:15], s66 offen offset:2048 lds
v_mfma_f32_16x16x32_bf16 v[100:103], a[192:195], v[160:163], 0
ds_read_b128 a[200:203], v56 offset:8192
ds_read_b128 a[76:79], v53 offset:8192
v_mfma_f32_16x16x32_bf16 v[116:119], a[192:195], v[164:167], 0
s_add_u32 s45, s45, 128
s_and_b32 s45, s45, 0x3ff
s_add_u32 m0, s47, 114688
v_mfma_f32_16x16x32_bf16 v[120:123], a[0:3], a[0:3], 0
buffer_load_dwordx4 v42, s[8:11], s45 offen lds
v_mfma_f32_16x16x32_bf16 v[124:127], v[28:31], a[0:3], 0
ds_read_b128 a[140:143], v55 offset:8192
ds_read_b128 a[204:207], v57 offset:8192
v_mfma_f32_16x16x32_bf16 v[120:123], a[4:7], a[4:7], v[120:123]
v_mfma_f32_16x16x32_bf16 v[124:127], v[28:31], a[4:7], v[124:127]
buffer_load_dwordx4 v43, s[8:11], s45 offen offset:1024 lds
v_mfma_f32_16x16x32_bf16 v[120:123], a[8:11], a[8:11], v[120:123]
v_mfma_f32_16x16x32_bf16 v[124:127], v[28:31], a[8:11], v[124:127]
v_mfma_f32_16x16x32_bf16 v[120:123], a[12:15], a[12:15], v[120:123]
v_mfma_f32_16x16x32_bf16 v[124:127], v[28:31], a[12:15], v[124:127]
s_waitcnt lgkmcnt(0)
s_waitcnt vmcnt(6)
s_barrier
ds_read_b64_tr_b16 v[176:177], v58 offset:24576
ds_read_b64_tr_b16 v[178:179], v58 offset:25088
v_mfma_f32_16x16x32_bf16 v[184:187], v[28:31], v[168:171], v[184:187]
s_add_u32 m0, s48, -1024
ds_read_b64_tr_b16 v[180:181], v58 offset:25600
v_mfma_f32_16x16x32_bf16 v[188:191], v[28:31], v[172:175], v[188:191]
buffer_load_dwordx4 v44, s[12:15], s67 offen offset:1024 lds
v_mfma_f32_16x16x32_bf16 v[88:91], a[4:7], v[168:171], v[88:91]
ds_read_b64_tr_b16 v[182:183], v58 offset:26112
ds_read_b128 a[16:19], v50 offset:32768
v_mfma_f32_16x16x32_bf16 v[104:107], a[4:7], v[172:175], v[104:107]
ds_read_b128 a[20:23], v51 offset:32768
ds_read_b64_tr_b16 v[160:161], v58 offset:32768
v_mfma_f32_16x16x32_bf16 v[92:95], a[68:71], v[168:171], v[92:95]
ds_read_b64_tr_b16 v[162:163], v58 offset:33280
ds_read_b64_tr_b16 v[164:165], v58 offset:33792
v_mfma_f32_16x16x32_bf16 v[108:111], a[68:71], v[172:175], v[108:111]
buffer_load_dwordx4 v44, s[12:15], s67 offen offset:2048 lds
v_mfma_f32_16x16x32_bf16 v[96:99], a[132:135], v[168:171], v[96:99]
ds_read_b64_tr_b16 v[166:167], v58 offset:34304
ds_read_b128 a[80:83], v52 offset:32768
v_mfma_f32_16x16x32_bf16 v[112:115], a[132:135], v[172:175], v[112:115]
ds_read_b128 a[144:147], v54 offset:32768
ds_read_b128 a[208:211], v56 offset:32768
v_mfma_f32_16x16x32_bf16 v[100:103], a[196:199], v[168:171], v[100:103]
s_add_u32 m0, s48, 1024
ds_read_b128 a[84:87], v53 offset:32768
v_mfma_f32_16x16x32_bf16 v[116:119], a[196:199], v[172:175], v[116:119]
buffer_load_dwordx4 v45, s[12:15], s67 offen offset:1024 lds
s_waitcnt lgkmcnt(8)
v_mfma_f32_16x16x32_bf16 v[120:123], a[16:19], a[16:19], v[120:123]
ds_read_b128 a[148:151], v55 offset:32768
ds_read_b128 a[212:215], v57 offset:32768
v_mfma_f32_16x16x32_bf16 v[124:127], v[28:31], a[16:19], v[124:127]
v_mfma_f32_16x16x32_bf16 v[120:123], a[20:23], a[20:23], v[120:123]
v_mfma_f32_16x16x32_bf16 v[124:127], v[28:31], a[20:23], v[124:127]
buffer_load_dwordx4 v45, s[12:15], s67 offen offset:2048 lds
v_mfma_f32_16x16x32_bf16 v[184:187], v[28:31], v[176:179], v[184:187]
v_mfma_f32_16x16x32_bf16 v[188:191], v[28:31], v[180:183], v[188:191]
v_mfma_f32_16x16x32_bf16 v[88:91], a[8:11], v[176:179], v[88:91]
s_add_u32 s45, s45, 128
s_and_b32 s45, s45, 0x3ff
s_add_u32 m0, s47, 65536
v_mfma_f32_16x16x32_bf16 v[104:107], a[8:11], v[180:183], v[104:107]
buffer_load_dwordx4 v42, s[8:11], s45 offen lds
v_mfma_f32_16x16x32_bf16 v[92:95], a[72:75], v[176:179], v[92:95]
v_mfma_f32_16x16x32_bf16 v[108:111], a[72:75], v[180:183], v[108:111]
v_mfma_f32_16x16x32_bf16 v[96:99], a[136:139], v[176:179], v[96:99]
v_mfma_f32_16x16x32_bf16 v[112:115], a[136:139], v[180:183], v[112:115]
buffer_load_dwordx4 v43, s[8:11], s45 offen offset:1024 lds
v_mfma_f32_16x16x32_bf16 v[100:103], a[200:203], v[176:179], v[100:103]
v_mfma_f32_16x16x32_bf16 v[116:119], a[200:203], v[180:183], v[116:119]
s_waitcnt lgkmcnt(0)
s_waitcnt vmcnt(6)
s_barrier
ds_read_b64_tr_b16 v[168:169], v58 offset:49152
ds_read_b64_tr_b16 v[170:171], v58 offset:49664
v_mfma_f32_16x16x32_bf16 v[184:187], v[28:31], v[160:163], v[184:187]
s_add_u32 m0, s48, 23552
ds_read_b64_tr_b16 v[172:173], v58 offset:50176
v_mfma_f32_16x16x32_bf16 v[188:191], v[28:31], v[164:167], v[188:191]
buffer_load_dwordx4 v44, s[12:15], s68 offen offset:1024 lds
v_mfma_f32_16x16x32_bf16 v[88:91], a[12:15], v[160:163], v[88:91]
ds_read_b64_tr_b16 v[174:175], v58 offset:50688
ds_read_b128 a[24:27], v50 offset:57344
v_mfma_f32_16x16x32_bf16 v[104:107], a[12:15], v[164:167], v[104:107]
ds_read_b128 a[28:31], v51 offset:57344
ds_read_b64_tr_b16 v[176:177], v58 offset:57344
v_mfma_f32_16x16x32_bf16 v[92:95], a[76:79], v[160:163], v[92:95]
ds_read_b64_tr_b16 v[178:179], v58 offset:57856
ds_read_b64_tr_b16 v[180:181], v58 offset:58368
v_mfma_f32_16x16x32_bf16 v[108:111], a[76:79], v[164:167], v[108:111]
buffer_load_dwordx4 v44, s[12:15], s68 offen offset:2048 lds
v_mfma_f32_16x16x32_bf16 v[96:99], a[140:143], v[160:163], v[96:99]
ds_read_b64_tr_b16 v[182:183], v58 offset:58880
ds_read_b128 a[88:91], v52 offset:57344
v_mfma_f32_16x16x32_bf16 v[112:115], a[140:143], v[164:167], v[112:115]
ds_read_b128 a[152:155], v54 offset:57344
ds_read_b128 a[216:219], v56 offset:57344
v_mfma_f32_16x16x32_bf16 v[100:103], a[204:207], v[160:163], v[100:103]
s_add_u32 m0, s48, 25600
ds_read_b128 a[92:95], v53 offset:57344
v_mfma_f32_16x16x32_bf16 v[116:119], a[204:207], v[164:167], v[116:119]
buffer_load_dwordx4 v45, s[12:15], s68 offen offset:1024 lds
s_waitcnt lgkmcnt(8)
v_mfma_f32_16x16x32_bf16 v[120:123], a[24:27], a[24:27], v[120:123]
ds_read_b128 a[156:159], v55 offset:57344
ds_read_b128 a[220:223], v57 offset:57344
v_mfma_f32_16x16x32_bf16 v[124:127], v[28:31], a[24:27], v[124:127]
v_mfma_f32_16x16x32_bf16 v[120:123], a[28:31], a[28:31], v[120:123]
v_mfma_f32_16x16x32_bf16 v[124:127], v[28:31], a[28:31], v[124:127]
buffer_load_dwordx4 v45, s[12:15], s68 offen offset:2048 lds
v_mfma_f32_16x16x32_bf16 v[184:187], v[28:31], v[168:171], v[184:187]
v_mfma_f32_16x16x32_bf16 v[188:191], v[28:31], v[172:175], v[188:191]
v_mfma_f32_16x16x32_bf16 v[88:91], a[16:19], v[168:171], v[88:91]
s_add_u32 s45, s45, 128
s_and_b32 s45, s45, 0x3ff
s_add_u32 m0, s47, 90112
v_mfma_f32_16x16x32_bf16 v[104:107], a[16:19], v[172:175], v[104:107]
buffer_load_dwordx4 v42, s[8:11], s45 offen lds
v_mfma_f32_16x16x32_bf16 v[92:95], a[80:83], v[168:171], v[92:95]
v_mfma_f32_16x16x32_bf16 v[108:111], a[80:83], v[172:175], v[108:111]
v_mfma_f32_16x16x32_bf16 v[96:99], a[144:147], v[168:171], v[96:99]
v_mfma_f32_16x16x32_bf16 v[112:115], a[144:147], v[172:175], v[112:115]
buffer_load_dwordx4 v43, s[8:11], s45 offen offset:1024 lds
v_mfma_f32_16x16x32_bf16 v[100:103], a[208:211], v[168:171], v[100:103]
v_mfma_f32_16x16x32_bf16 v[116:119], a[208:211], v[172:175], v[116:119]
s_waitcnt lgkmcnt(0)
s_waitcnt vmcnt(6)
s_barrier
ds_read_b64_tr_b16 v[160:161], v58 offset:0
ds_read_b64_tr_b16 v[162:163], v58 offset:512
v_mfma_f32_16x16x32_bf16 v[184:187], v[28:31], v[176:179], v[184:187]
s_add_u32 m0, s48, 48128
ds_read_b64_tr_b16 v[164:165], v58 offset:1024
v_mfma_f32_16x16x32_bf16 v[188:191], v[28:31], v[180:183], v[188:191]
buffer_load_dwordx4 v44, s[12:15], s69 offen offset:1024 lds
v_mfma_f32_16x16x32_bf16 v[88:91], a[20:23], v[176:179], v[88:91]
ds_read_b64_tr_b16 v[166:167], v58 offset:1536
ds_read_b128 a[32:35], v50 offset:8192
v_mfma_f32_16x16x32_bf16 v[104:107], a[20:23], v[180:183], v[104:107]
ds_read_b128 a[36:39], v51 offset:8192
ds_read_b64_tr_b16 v[168:169], v58 offset:8192
v_mfma_f32_16x16x32_bf16 v[92:95], a[84:87], v[176:179], v[92:95]
ds_read_b64_tr_b16 v[170:171], v58 offset:8704
ds_read_b64_tr_b16 v[172:173], v58 offset:9216
v_mfma_f32_16x16x32_bf16 v[108:111], a[84:87], v[180:183], v[108:111]
buffer_load_dwordx4 v44, s[12:15], s69 offen offset:2048 lds
v_mfma_f32_16x16x32_bf16 v[96:99], a[148:151], v[176:179], v[96:99]
ds_read_b64_tr_b16 v[174:175], v58 offset:9728
ds_read_b128 a[96:99], v52 offset:8192
v_mfma_f32_16x16x32_bf16 v[112:115], a[148:151], v[180:183], v[112:115]
ds_read_b128 a[160:163], v54 offset:8192
ds_read_b128 a[224:227], v56 offset:8192
v_mfma_f32_16x16x32_bf16 v[100:103], a[212:215], v[176:179], v[100:103]
s_add_u32 m0, s48, 50176
ds_read_b128 a[100:103], v53 offset:8192
v_mfma_f32_16x16x32_bf16 v[116:119], a[212:215], v[180:183], v[116:119]
buffer_load_dwordx4 v45, s[12:15], s69 offen offset:1024 lds
s_waitcnt lgkmcnt(8)
v_mfma_f32_16x16x32_bf16 v[120:123], a[32:35], a[32:35], v[120:123]
ds_read_b128 a[164:167], v55 offset:8192
ds_read_b128 a[228:231], v57 offset:8192
v_mfma_f32_16x16x32_bf16 v[124:127], v[28:31], a[32:35], v[124:127]
v_mfma_f32_16x16x32_bf16 v[120:123], a[36:39], a[36:39], v[120:123]
v_mfma_f32_16x16x32_bf16 v[124:127], v[28:31], a[36:39], v[124:127]
buffer_load_dwordx4 v45, s[12:15], s69 offen offset:2048 lds
v_mfma_f32_16x16x32_bf16 v[184:187], v[28:31], v[160:163], v[184:187]
v_mfma_f32_16x16x32_bf16 v[188:191], v[28:31], v[164:167], v[188:191]
v_mfma_f32_16x16x32_bf16 v[88:91], a[24:27], v[160:163], v[88:91]
s_add_u32 s45, s45, 128
s_and_b32 s45, s45, 0x3ff
s_add_u32 m0, s47, 114688
v_mfma_f32_16x16x32_bf16 v[104:107], a[24:27], v[164:167], v[104:107]
buffer_load_dwordx4 v42, s[8:11], s45 offen lds
v_mfma_f32_16x16x32_bf16 v[92:95], a[88:91], v[160:163], v[92:95]
v_mfma_f32_16x16x32_bf16 v[108:111], a[88:91], v[164:167], v[108:111]
v_mfma_f32_16x16x32_bf16 v[96:99], a[152:155], v[160:163], v[96:99]
v_mfma_f32_16x16x32_bf16 v[112:115], a[152:155], v[164:167], v[112:115]
buffer_load_dwordx4 v43, s[8:11], s45 offen offset:1024 lds
v_mfma_f32_16x16x32_bf16 v[100:103], a[216:219], v[160:163], v[100:103]
v_mfma_f32_16x16x32_bf16 v[116:119], a[216:219], v[164:167], v[116:119]
s_waitcnt lgkmcnt(0)
s_waitcnt vmcnt(6)
s_barrier
ds_read_b64_tr_b16 v[176:177], v58 offset:24576
ds_read_b64_tr_b16 v[178:179], v58 offset:25088
v_mfma_f32_16x16x32_bf16 v[184:187], v[28:31], v[168:171], v[184:187]
s_add_u32 m0, s48, -1024
ds_read_b64_tr_b16 v[180:181], v58 offset:25600
v_mfma_f32_16x16x32_bf16 v[188:191], v[28:31], v[172:175], v[188:191]
buffer_load_dwordx4 v44, s[12:15], s70 offen offset:1024 lds
v_mfma_f32_16x16x32_bf16 v[88:91], a[28:31], v[168:171], v[88:91]
ds_read_b64_tr_b16 v[182:183], v58 offset:26112
ds_read_b128 a[40:43], v50 offset:32768
v_mfma_f32_16x16x32_bf16 v[104:107], a[28:31], v[172:175], v[104:107]
ds_read_b128 a[44:47], v51 offset:32768
ds_read_b64_tr_b16 v[160:161], v58 offset:32768
v_mfma_f32_16x16x32_bf16 v[92:95], a[92:95], v[168:171], v[92:95]
ds_read_b64_tr_b16 v[162:163], v58 offset:33280
ds_read_b64_tr_b16 v[164:165], v58 offset:33792
v_mfma_f32_16x16x32_bf16 v[108:111], a[92:95], v[172:175], v[108:111]
buffer_load_dwordx4 v44, s[12:15], s70 offen offset:2048 lds
v_mfma_f32_16x16x32_bf16 v[96:99], a[156:159], v[168:171], v[96:99]
ds_read_b64_tr_b16 v[166:167], v58 offset:34304
ds_read_b128 a[104:107], v52 offset:32768
v_mfma_f32_16x16x32_bf16 v[112:115], a[156:159], v[172:175], v[112:115]
ds_read_b128 a[168:171], v54 offset:32768
ds_read_b128 a[232:235], v56 offset:32768
v_mfma_f32_16x16x32_bf16 v[100:103], a[220:223], v[168:171], v[100:103]
s_add_u32 m0, s48, 1024
ds_read_b128 a[108:111], v53 offset:32768
v_mfma_f32_16x16x32_bf16 v[116:119], a[220:223], v[172:175], v[116:119]
buffer_load_dwordx4 v45, s[12:15], s70 offen offset:1024 lds
s_waitcnt lgkmcnt(8)
v_mfma_f32_16x16x32_bf16 v[120:123], a[40:43], a[40:43], v[120:123]
ds_read_b128 a[172:175], v55 offset:32768
ds_read_b128 a[236:239], v57 offset:32768
v_mfma_f32_16x16x32_bf16 v[124:127], v[28:31], a[40:43], v[124:127]
v_mfma_f32_16x16x32_bf16 v[120:123], a[44:47], a[44:47], v[120:123]
v_mfma_f32_16x16x32_bf16 v[124:127], v[28:31], a[44:47], v[124:127]
buffer_load_dwordx4 v45, s[12:15], s70 offen offset:2048 lds
v_mfma_f32_16x16x32_bf16 v[184:187], v[28:31], v[176:179], v[184:187]
v_mfma_f32_16x16x32_bf16 v[188:191], v[28:31], v[180:183], v[188:191]
v_mfma_f32_16x16x32_bf16 v[88:91], a[32:35], v[176:179], v[88:91]
s_add_u32 s45, s45, 128
s_and_b32 s45, s45, 0x3ff
s_add_u32 m0, s47, 65536
v_mfma_f32_16x16x32_bf16 v[104:107], a[32:35], v[180:183], v[104:107]
buffer_load_dwordx4 v42, s[8:11], s45 offen lds
v_mfma_f32_16x16x32_bf16 v[92:95], a[96:99], v[176:179], v[92:95]
v_mfma_f32_16x16x32_bf16 v[108:111], a[96:99], v[180:183], v[108:111]
v_mfma_f32_16x16x32_bf16 v[96:99], a[160:163], v[176:179], v[96:99]
v_mfma_f32_16x16x32_bf16 v[112:115], a[160:163], v[180:183], v[112:115]
buffer_load_dwordx4 v43, s[8:11], s45 offen offset:1024 lds
v_mfma_f32_16x16x32_bf16 v[100:103], a[224:227], v[176:179], v[100:103]
v_mfma_f32_16x16x32_bf16 v[116:119], a[224:227], v[180:183], v[116:119]
s_waitcnt lgkmcnt(0)
s_waitcnt vmcnt(6)
s_barrier
ds_read_b64_tr_b16 v[168:169], v58 offset:49152
ds_read_b64_tr_b16 v[170:171], v58 offset:49664
v_mfma_f32_16x16x32_bf16 v[184:187], v[28:31], v[160:163], v[184:187]
s_add_u32 m0, s48, 23552
ds_read_b64_tr_b16 v[172:173], v58 offset:50176
v_mfma_f32_16x16x32_bf16 v[188:191], v[28:31], v[164:167], v[188:191]
buffer_load_dwordx4 v44, s[12:15], s71 offen offset:1024 lds
v_mfma_f32_16x16x32_bf16 v[88:91], a[36:39], v[160:163], v[88:91]
ds_read_b64_tr_b16 v[174:175], v58 offset:50688
ds_read_b128 a[48:51], v50 offset:57344
v_mfma_f32_16x16x32_bf16 v[104:107], a[36:39], v[164:167], v[104:107]
ds_read_b128 a[52:55], v51 offset:57344
ds_read_b64_tr_b16 v[176:177], v58 offset:57344
v_mfma_f32_16x16x32_bf16 v[92:95], a[100:103], v[160:163], v[92:95]
ds_read_b64_tr_b16 v[178:179], v58 offset:57856
ds_read_b64_tr_b16 v[180:181], v58 offset:58368
v_mfma_f32_16x16x32_bf16 v[108:111], a[100:103], v[164:167], v[108:111]
buffer_load_dwordx4 v44, s[12:15], s71 offen offset:2048 lds
v_mfma_f32_16x16x32_bf16 v[96:99], a[164:167], v[160:163], v[96:99]
ds_read_b64_tr_b16 v[182:183], v58 offset:58880
ds_read_b128 a[112:115], v52 offset:57344
v_mfma_f32_16x16x32_bf16 v[112:115], a[164:167], v[164:167], v[112:115]
ds_read_b128 a[176:179], v54 offset:57344
ds_read_b128 a[240:243], v56 offset:57344
v_mfma_f32_16x16x32_bf16 v[100:103], a[228:231], v[160:163], v[100:103]
s_add_u32 m0, s48, 25600
ds_read_b128 a[116:119], v53 offset:57344
v_mfma_f32_16x16x32_bf16 v[116:119], a[228:231], v[164:167], v[116:119]
buffer_load_dwordx4 v45, s[12:15], s71 offen offset:1024 lds
s_waitcnt lgkmcnt(8)
v_mfma_f32_16x16x32_bf16 v[120:123], a[48:51], a[48:51], v[120:123]
ds_read_b128 a[180:183], v55 offset:57344
ds_read_b128 a[244:247], v57 offset:57344
v_mfma_f32_16x16x32_bf16 v[124:127], v[28:31], a[48:51], v[124:127]
v_mfma_f32_16x16x32_bf16 v[120:123], a[52:55], a[52:55], v[120:123]
v_mfma_f32_16x16x32_bf16 v[124:127], v[28:31], a[52:55], v[124:127]
buffer_load_dwordx4 v45, s[12:15], s71 offen offset:2048 lds
v_mfma_f32_16x16x32_bf16 v[184:187], v[28:31], v[168:171], v[184:187]
v_mfma_f32_16x16x32_bf16 v[188:191], v[28:31], v[172:175], v[188:191]
s_cmp_lg_u32 s55, 0
s_cbranch_scc1 L_nz2
s_mul_i32 s7, s2, 16
s_mov_b64 exec, 1
buffer_store_dword v7, off, s[20:23], s7 sc1
s_mov_b64 exec, -1
L_nz2:
v_mfma_f32_16x16x32_bf16 v[88:91], a[40:43], v[168:171], v[88:91]
s_add_u32 m0, s47, 0
v_mfma_f32_16x16x32_bf16 v[104:107], a[40:43], v[172:175], v[104:107]
buffer_load_dwordx4 v44, s[12:15], s64 offen lds
v_mfma_f32_16x16x32_bf16 v[92:95], a[104:107], v[168:171], v[92:95]
v_mfma_f32_16x16x32_bf16 v[108:111], a[104:107], v[172:175], v[108:111]
v_mfma_f32_16x16x32_bf16 v[96:99], a[168:171], v[168:171], v[96:99]
s_add_u32 m0, s47, 1024
v_mfma_f32_16x16x32_bf16 v[112:115], a[168:171], v[172:175], v[112:115]
buffer_load_dwordx4 v45, s[12:15], s64 offen lds
v_mfma_f32_16x16x32_bf16 v[100:103], a[232:235], v[168:171], v[100:103]
v_mfma_f32_16x16x32_bf16 v[116:119], a[232:235], v[172:175], v[116:119]
s_waitcnt lgkmcnt(0)
s_waitcnt vmcnt(6)
s_barrier
ds_read_b128 a[56:59], v50 offset:8192
ds_read_b128 a[60:63], v51 offset:8192
v_mfma_f32_16x16x32_bf16 v[184:187], v[28:31], v[176:179], v[184:187]
s_add_u32 m0, s47, 8192
ds_read_b64_tr_b16 v[160:161], v58 offset:0
v_mfma_f32_16x16x32_bf16 v[188:191], v[28:31], v[180:183], v[188:191]
buffer_load_dwordx4 v44, s[12:15], s65 offen lds
v_mfma_f32_16x16x32_bf16 v[88:91], a[44:47], v[176:179], v[88:91]
ds_read_b64_tr_b16 v[162:163], v58 offset:512
ds_read_b64_tr_b16 v[164:165], v58 offset:1024
v_mfma_f32_16x16x32_bf16 v[104:107], a[44:47], v[180:183], v[104:107]
ds_read_b64_tr_b16 v[166:167], v58 offset:1536
ds_read_b64_tr_b16 v[168:169], v58 offset:8192
v_mfma_f32_16x16x32_bf16 v[92:95], a[108:111], v[176:179], v[92:95]
s_add_u32 m0, s47, 9216
ds_read_b64_tr_b16 v[170:171], v58 offset:8704
s_waitcnt lgkmcnt(6)
v_mfma_f32_16x16x32_bf16 v[120:123], a[56:59], a[56:59], v[120:123]
buffer_load_dwordx4 v45, s[12:15], s65 offen lds
v_mfma_f32_16x16x32_bf16 v[124:127], v[28:31], a[56:59], v[124:127]
ds_read_b64_tr_b16 v[172:173], v58 offset:9216
ds_read_b64_tr_b16 v[174:175], v58 offset:9728
v_mfma_f32_16x16x32_bf16 v[120:123], a[60:63], a[60:63], v[120:123]
ds_read_b128 a[120:123], v52 offset:8192
ds_read_b128 a[184:187], v54 offset:8192
v_mfma_f32_16x16x32_bf16 v[124:127], v[28:31], a[60:63], v[124:127]
s_add_u32 m0, s47, 16384
ds_read_b128 a[248:251], v56 offset:8192
v_mfma_f32_16x16x32_bf16 v[108:111], a[108:111], v[180:183], v[108:111]
buffer_load_dwordx4 v44, s[12:15], s66 offen lds
v_mfma_f32_16x16x32_bf16 v[96:99], a[172:175], v[176:179], v[96:99]
ds_read_b128 a[124:127], v53 offset:8192
ds_read_b128 a[188:191], v55 offset:8192
v_mfma_f32_16x16x32_bf16 v[112:115], a[172:175], v[180:183], v[112:115]
ds_read_b128 a[252:255], v57 offset:8192
v_cndmask_b32 v1, v120, v121, s[96:97]
v_cndmask_b32 v1, v1, v122, s[98:99]
v_mfma_f32_16x16x32_bf16 v[100:103], a[236:239], v[176:179], v[100:103]
s_add_u32 m0, s47, 17408
v_cndmask_b32 v1, v1, v123, s[100:101]
v_mul_f32 v2, 0xbb000000, v124
v_mfma_f32_16x16x32_bf16 v[116:119], a[236:239], v[180:183], v[116:119]
buffer_load_dwordx4 v45, s[12:15], s66 offen lds
v_mul_f32 v1, 0x3b000000, v1
s_waitcnt lgkmcnt(10)
v_mfma_f32_16x16x32_bf16 v[184:187], v[28:31], v[160:163], v[184:187]
v_fma_f32 v1, -v2, v2, v1
v_max_f32 v1, 0, v1
v_add_f32 v1, 0x3727c5ac, v1
v_mfma_f32_16x16x32_bf16 v[188:191], v[28:31], v[164:167], v[188:191]
v_rsq_f32 v1, v1
s_nop 0
v_mul_f32 v1, 0x3fb8aa3b, v1
v_mfma_f32_16x16x32_bf16 v[88:91], a[48:51], v[160:163], v[88:91]
s_add_u32 m0, s47, 24576
s_mov_b32 exec_lo, 0x00f0000f
s_mov_b32 exec_hi, 0xf0000f00
ds_write2st64_b32 v85, v2, v2 offset0:0 offset1:1
ds_write2st64_b32 v85, v1, v1 offset0:2 offset1:3
s_mov_b64 exec, -1
v_mfma_f32_16x16x32_bf16 v[104:107], a[48:51], v[164:167], v[104:107]
buffer_load_dwordx4 v44, s[12:15], s67 offen lds
v_mfma_f32_16x16x32_bf16 v[92:95], a[112:115], v[160:163], v[92:95]
v_mfma_f32_16x16x32_bf16 v[108:111], a[112:115], v[164:167], v[108:111]
v_mfma_f32_16x16x32_bf16 v[96:99], a[176:179], v[160:163], v[96:99]
s_add_u32 m0, s47, 25600
v_mfma_f32_16x16x32_bf16 v[112:115], a[176:179], v[164:167], v[112:115]
buffer_load_dwordx4 v45, s[12:15], s67 offen lds
v_mfma_f32_16x16x32_bf16 v[100:103], a[240:243], v[160:163], v[100:103]
v_mfma_f32_16x16x32_bf16 v[116:119], a[240:243], v[164:167], v[116:119]
s_waitcnt lgkmcnt(0)
s_waitcnt vmcnt(8)
s_barrier
s_add_u32 m0, s47, 32768
ds_read_b64_tr_b16 v[176:177], v58 offset:24576
ds_read_b64_tr_b16 v[178:179], v58 offset:25088
v_mfma_f32_16x16x32_bf16 v[184:187], v[28:31], v[168:171], v[184:187]
buffer_load_dwordx4 v44, s[12:15], s68 offen lds
v_mfma_f32_16x16x32_bf16 v[188:191], v[28:31], v[172:175], v[188:191]
ds_read_b64_tr_b16 v[180:181], v58 offset:25600
ds_read_b64_tr_b16 v[182:183], v58 offset:26112
v_mfma_f32_16x16x32_bf16 v[88:91], a[52:55], v[168:171], v[88:91]
s_add_u32 m0, s47, 33792
ds_read_b64_tr_b16 v[160:161], v58 offset:32768
v_mfma_f32_16x16x32_bf16 v[104:107], a[52:55], v[172:175], v[104:107]
buffer_load_dwordx4 v45, s[12:15], s68 offen lds
v_mfma_f32_16x16x32_bf16 v[92:95], a[116:119], v[168:171], v[92:95]
ds_read_b64_tr_b16 v[162:163], v58 offset:33280
ds_read_b64_tr_b16 v[164:165], v58 offset:33792
v_mfma_f32_16x16x32_bf16 v[108:111], a[116:119], v[172:175], v[108:111]
s_add_u32 m0, s47, 40960
ds_read_b64_tr_b16 v[166:167], v58 offset:34304
v_mfma_f32_16x16x32_bf16 v[96:99], a[180:183], v[168:171], v[96:99]
buffer_load_dwordx4 v44, s[12:15], s69 offen lds
v_mfma_f32_16x16x32_bf16 v[112:115], a[180:183], v[172:175], v[112:115]
ds_read_b128 v[128:131], v86 offset:0
ds_read_b128 v[144:147], v86 offset:512
v_mfma_f32_16x16x32_bf16 v[100:103], a[244:247], v[168:171], v[100:103]
s_add_u32 m0, s47, 41984
ds_read_b128 v[132:135], v86 offset:64
v_mfma_f32_16x16x32_bf16 v[116:119], a[244:247], v[172:175], v[116:119]
buffer_load_dwordx4 v45, s[12:15], s69 offen lds
s_waitcnt lgkmcnt(3)
v_mfma_f32_16x16x32_bf16 v[184:187], v[28:31], v[176:179], v[184:187]
ds_read_b128 v[148:151], v86 offset:576
ds_read_b128 v[136:139], v86 offset:128
v_mfma_f32_16x16x32_bf16 v[188:191], v[28:31], v[180:183], v[188:191]
s_add_u32 m0, s47, 49152
ds_read_b128 v[152:155], v86 offset:640
v_mfma_f32_16x16x32_bf16 v[184:187], v[28:31], v[160:163], v[184:187]
buffer_load_dwordx4 v44, s[12:15], s70 offen lds
v_mfma_f32_16x16x32_bf16 v[188:191], v[28:31], v[164:167], v[188:191]
ds_read_b128 v[140:143], v86 offset:192
ds_read_b128 v[156:159], v86 offset:704
v_mfma_f32_16x16x32_bf16 v[88:91], a[56:59], v[176:179], v[88:91]
s_add_u32 m0, s47, 50176
ds_read2_b32 v[192:193], v85 offset0:0 offset1:128
v_mfma_f32_16x16x32_bf16 v[104:107], a[56:59], v[180:183], v[104:107]
buffer_load_dwordx4 v45, s[12:15], s70 offen lds
v_mfma_f32_16x16x32_bf16 v[88:91], a[60:63], v[160:163], v[88:91]
ds_read2_b32 v[194:195], v85 offset0:16 offset1:144
ds_read2_b32 v[196:197], v85 offset0:32 offset1:160
v_mfma_f32_16x16x32_bf16 v[104:107], a[60:63], v[164:167], v[104:107]
s_add_u32 m0, s47, 57344
ds_read2_b32 v[198:199], v85 offset0:48 offset1:176
v_mfma_f32_16x16x32_bf16 v[92:95], a[120:123], v[176:179], v[92:95]
buffer_load_dwordx4 v44, s[12:15], s71 offen lds
v_mfma_f32_16x16x32_bf16 v[108:111], a[120:123], v[180:183], v[108:111]
v_mfma_f32_16x16x32_bf16 v[92:95], a[124:127], v[160:163], v[92:95]
s_add_u32 m0, s47, 58368
v_mfma_f32_16x16x32_bf16 v[108:111], a[124:127], v[164:167], v[108:111]
buffer_load_dwordx4 v45, s[12:15], s71 offen lds
v_mfma_f32_16x16x32_bf16 v[96:99], a[184:187], v[176:179], v[96:99]
v_mfma_f32_16x16x32_bf16 v[112:115], a[184:187], v[180:183], v[112:115]
v_mfma_f32_16x16x32_bf16 v[96:99], a[188:191], v[160:163], v[96:99]
buffer_load_dword v84, v87, s[20:23], 0 offen sc1
v_mfma_f32_16x16x32_bf16 v[112:115], a[188:191], v[164:167], v[112:115]
v_mfma_f32_16x16x32_bf16 v[100:103], a[248:251], v[176:179], v[100:103]
v_mfma_f32_16x16x32_bf16 v[116:119], a[248:251], v[180:183], v[116:119]
v_mfma_f32_16x16x32_bf16 v[100:103], a[252:255], v[160:163], v[100:103]
v_mfma_f32_16x16x32_bf16 v[116:119], a[252:255], v[164:167], v[116:119]
s_waitcnt lgkmcnt(0)
v_pk_fma_f32 v[88:89], v[128:129], v[184:185], v[88:89]
v_pk_fma_f32 v[104:105], v[128:129], v[188:189], v[104:105]
v_pk_mul_f32 v[88:89], v[88:89], v[144:145]
v_pk_mul_f32 v[104:105], v[104:105], v[144:145]
v_cvt_pk_bf16_f32 v168, v104, v105
v_exp_f32_e64 v200, v88 clamp
v_exp_f32_e64 v201, v89 clamp
v_pk_fma_f32 v[202:203], v[88:89], v[78:79], v[78:79] op_sel:[0,0,1] op_sel_hi:[1,0,1]
v_pk_add_f32 v[200:201], v[200:201], v[80:81]
v_max_f32 v202, v202, v200
v_max_f32 v203, v203, v201
v_cvt_pk_bf16_f32 v208, v202, v203
v_pk_fma_f32 v[90:91], v[130:131], v[184:185], v[90:91]
v_pk_fma_f32 v[106:107], v[130:131], v[188:189], v[106:107]
v_pk_mul_f32 v[90:91], v[90:91], v[146:147]
v_pk_mul_f32 v[106:107], v[106:107], v[146:147]
v_cvt_pk_bf16_f32 v169, v106, v107
v_exp_f32_e64 v204, v90 clamp
v_exp_f32_e64 v205, v91 clamp
v_pk_fma_f32 v[206:207], v[90:91], v[78:79], v[78:79] op_sel:[0,0,1] op_sel_hi:[1,0,1]
v_pk_add_f32 v[204:205], v[204:205], v[80:81]
v_max_f32 v206, v206, v204
v_max_f32 v207, v207, v205
v_cvt_pk_bf16_f32 v209, v206, v207
v_pk_fma_f32 v[92:93], v[132:133], v[184:185], v[92:93]
v_pk_fma_f32 v[108:109], v[132:133], v[188:189], v[108:109]
v_pk_mul_f32 v[92:93], v[92:93], v[148:149]
v_pk_mul_f32 v[108:109], v[108:109], v[148:149]
v_cvt_pk_bf16_f32 v170, v108, v109
v_exp_f32_e64 v200, v92 clamp
v_exp_f32_e64 v201, v93 clamp
v_pk_fma_f32 v[202:203], v[92:93], v[78:79], v[78:79] op_sel:[0,0,1] op_sel_hi:[1,0,1]
v_pk_add_f32 v[200:201], v[200:201], v[80:81]
v_max_f32 v202, v202, v200
v_max_f32 v203, v203, v201
v_cvt_pk_bf16_f32 v210, v202, v203
v_pk_fma_f32 v[94:95], v[134:135], v[184:185], v[94:95]
v_pk_fma_f32 v[110:111], v[134:135], v[188:189], v[110:111]
v_pk_mul_f32 v[94:95], v[94:95], v[150:151]
v_pk_mul_f32 v[110:111], v[110:111], v[150:151]
v_cvt_pk_bf16_f32 v171, v110, v111
v_exp_f32_e64 v204, v94 clamp
v_exp_f32_e64 v205, v95 clamp
v_pk_fma_f32 v[206:207], v[94:95], v[78:79], v[78:79] op_sel:[0,0,1] op_sel_hi:[1,0,1]
v_pk_add_f32 v[204:205], v[204:205], v[80:81]
v_max_f32 v206, v206, v204
v_max_f32 v207, v207, v205
v_cvt_pk_bf16_f32 v211, v206, v207
v_pk_fma_f32 v[96:97], v[136:137], v[184:185], v[96:97]
v_pk_fma_f32 v[112:113], v[136:137], v[188:189], v[112:113]
v_pk_mul_f32 v[96:97], v[96:97], v[152:153]
v_pk_mul_f32 v[112:113], v[112:113], v[152:153]
v_cvt_pk_bf16_f32 v172, v112, v113
v_exp_f32_e64 v200, v96 clamp
v_exp_f32_e64 v201, v97 clamp
v_pk_fma_f32 v[202:203], v[96:97], v[78:79], v[78:79] op_sel:[0,0,1] op_sel_hi:[1,0,1]
v_pk_add_f32 v[200:201], v[200:201], v[80:81]
v_max_f32 v202, v202, v200
v_max_f32 v203, v203, v201
v_cvt_pk_bf16_f32 v212, v202, v203
v_pk_fma_f32 v[98:99], v[138:139], v[184:185], v[98:99]
v_pk_fma_f32 v[114:115], v[138:139], v[188:189], v[114:115]
v_pk_mul_f32 v[98:99], v[98:99], v[154:155]
v_pk_mul_f32 v[114:115], v[114:115], v[154:155]
v_cvt_pk_bf16_f32 v173, v114, v115
v_exp_f32_e64 v204, v98 clamp
v_exp_f32_e64 v205, v99 clamp
v_pk_fma_f32 v[206:207], v[98:99], v[78:79], v[78:79] op_sel:[0,0,1] op_sel_hi:[1,0,1]
v_pk_add_f32 v[204:205], v[204:205], v[80:81]
v_max_f32 v206, v206, v204
v_max_f32 v207, v207, v205
v_cvt_pk_bf16_f32 v213, v206, v207
v_pk_fma_f32 v[100:101], v[140:141], v[184:185], v[100:101]
v_pk_fma_f32 v[116:117], v[140:141], v[188:189], v[116:117]
v_pk_mul_f32 v[100:101], v[100:101], v[156:157]
v_pk_mul_f32 v[116:117], v[116:117], v[156:157]
v_cvt_pk_bf16_f32 v174, v116, v117
v_exp_f32_e64 v200, v100 clamp
v_exp_f32_e64 v201, v101 clamp
v_pk_fma_f32 v[202:203], v[100:101], v[78:79], v[78:79] op_sel:[0,0,1] op_sel_hi:[1,0,1]
v_pk_add_f32 v[200:201], v[200:201], v[80:81]
v_max_f32 v202, v202, v200
v_max_f32 v203, v203, v201
v_cvt_pk_bf16_f32 v214, v202, v203
v_pk_fma_f32 v[102:103], v[142:143], v[184:185], v[102:103]
v_pk_fma_f32 v[118:119], v[142:143], v[188:189], v[118:119]
v_pk_mul_f32 v[102:103], v[102:103], v[158:159]
v_pk_mul_f32 v[118:119], v[118:119], v[158:159]
v_cvt_pk_bf16_f32 v175, v118, v119
v_exp_f32_e64 v204, v102 clamp
v_exp_f32_e64 v205, v103 clamp
v_pk_fma_f32 v[206:207], v[102:103], v[78:79], v[78:79] op_sel:[0,0,1] op_sel_hi:[1,0,1]
v_pk_add_f32 v[204:205], v[204:205], v[80:81]
v_mfma_f32_16x16x32_bf16 v[120:123], v[208:211], v[168:171], 0
v_max_f32 v206, v206, v204
v_max_f32 v207, v207, v205
v_cvt_pk_bf16_f32 v215, v206, v207
s_nop 1
v_mfma_f32_16x16x32_bf16 v[120:123], v[212:215], v[172:175], v[120:123]
v_mfma_f32_16x16x32_bf16 v[124:127], v[208:211], v[28:31], 0
v_mfma_f32_16x16x32_bf16 v[124:127], v[212:215], v[28:31], v[124:127]
s_nop 5
v_cvt_pk_bf16_f32 v128, v120, v121
v_cvt_pk_bf16_f32 v129, v122, v123
s_nop 0
v_permlane32_swap_b32 v128, v130
v_permlane32_swap_b32 v129, v131
s_mov_b32 exec_hi, 0
buffer_store_dwordx4 v[128:131], v5, s[16:19], s57 offen sc1
s_mov_b64 exec, -1
v_cvt_pk_bf16_f32 v132, v124, v125
v_cvt_pk_bf16_f32 v133, v126, v127
s_nop 0
v_permlane32_swap_b32 v132, v134
v_permlane32_swap_b32 v133, v135
s_waitcnt vmcnt(2)
s_barrier
ds_read_b64_tr_b16 v[144:145], v59 offset:0
ds_read_b64_tr_b16 v[146:147], v59 offset:512
ds_read_b64_tr_b16 v[148:149], v59 offset:4096
ds_read_b64_tr_b16 v[150:151], v59 offset:4608
ds_read_b64_tr_b16 v[152:153], v59 offset:8192
ds_read_b64_tr_b16 v[154:155], v59 offset:8704
s_lshl_b32 s47, s3, 10
s_xor_b32 s7, s6, 0
s_mul_i32 s7, s7, 458752
s_add_u32 s64, s7, s46
s_xor_b32 s7, s6, 1
s_mul_i32 s7, s7, 458752
s_add_u32 s65, s7, s46
s_xor_b32 s7, s6, 2
s_mul_i32 s7, s7, 458752
s_add_u32 s66, s7, s46
s_xor_b32 s7, s6, 3
s_mul_i32 s7, s7, 458752
s_add_u32 s67, s7, s46
s_waitcnt lgkmcnt(4)
v_mfma_f32_16x16x32_bf16 v[88:91], v[144:147], a[0:3], 0
buffer_load_dword v40, v39, s[28:31], 0 offen
v_mfma_f32_16x16x32_bf16 v[92:95], v[144:147], a[64:67], 0
ds_read_b64_tr_b16 v[156:157], v59 offset:12288
v_mfma_f32_16x16x32_bf16 v[96:99], v[144:147], a[128:131], 0
s_lshl_b32 s98, s56, 12
s_add_u32 s98, s98, 0x700000
v_mfma_f32_16x16x32_bf16 v[100:103], v[144:147], a[192:195], 0
ds_read_b64_tr_b16 v[158:159], v59 offset:12800
v_mfma_f32_16x16x32_bf16 v[184:187], v[144:147], v[28:31], 0
s_waitcnt lgkmcnt(4)
v_mfma_f32_16x16x32_bf16 v[88:91], v[148:151], a[4:7], v[88:91]
v_mfma_f32_16x16x32_bf16 v[92:95], v[148:151], a[68:71], v[92:95]
ds_read_b64_tr_b16 v[144:145], v59 offset:16384
v_mfma_f32_16x16x32_bf16 v[96:99], v[148:151], a[132:135], v[96:99]
v_mfma_f32_16x16x32_bf16 v[100:103], v[148:151], a[196:199], v[100:103]
ds_read_b64_tr_b16 v[146:147], v59 offset:16896
v_mfma_f32_16x16x32_bf16 v[184:187], v[148:151], v[28:31], v[184:187]
s_waitcnt lgkmcnt(4)
v_mfma_f32_16x16x32_bf16 v[88:91], v[152:155], a[8:11], v[88:91]
v_mfma_f32_16x16x32_bf16 v[92:95], v[152:155], a[72:75], v[92:95]
ds_read_b64_tr_b16 v[148:149], v59 offset:20480
v_mfma_f32_16x16x32_bf16 v[96:99], v[152:155], a[136:139], v[96:99]
v_mfma_f32_16x16x32_bf16 v[100:103], v[152:155], a[200:203], v[100:103]
ds_read_b64_tr_b16 v[150:151], v59 offset:20992
v_mfma_f32_16x16x32_bf16 v[184:187], v[152:155], v[28:31], v[184:187]
s_waitcnt lgkmcnt(4)
v_mfma_f32_16x16x32_bf16 v[88:91], v[156:159], a[12:15], v[88:91]
v_mfma_f32_16x16x32_bf16 v[92:95], v[156:159], a[76:79], v[92:95]
ds_read_b64_tr_b16 v[152:153], v59 offset:24576
v_mfma_f32_16x16x32_bf16 v[96:99], v[156:159], a[140:143], v[96:99]
v_mfma_f32_16x16x32_bf16 v[100:103], v[156:159], a[204:207], v[100:103]
ds_read_b64_tr_b16 v[154:155], v59 offset:25088
v_mfma_f32_16x16x32_bf16 v[184:187], v[156:159], v[28:31], v[184:187]
s_waitcnt lgkmcnt(4)
v_mfma_f32_16x16x32_bf16 v[88:91], v[144:147], a[16:19], v[88:91]
v_mfma_f32_16x16x32_bf16 v[92:95], v[144:147], a[80:83], v[92:95]
ds_read_b64_tr_b16 v[156:157], v59 offset:28672
v_mfma_f32_16x16x32_bf16 v[96:99], v[144:147], a[144:147], v[96:99]
v_mfma_f32_16x16x32_bf16 v[100:103], v[144:147], a[208:211], v[100:103]
ds_read_b64_tr_b16 v[158:159], v59 offset:29184
v_mfma_f32_16x16x32_bf16 v[184:187], v[144:147], v[28:31], v[184:187]
s_waitcnt lgkmcnt(4)
v_mfma_f32_16x16x32_bf16 v[88:91], v[148:151], a[20:23], v[88:91]
v_mfma_f32_16x16x32_bf16 v[92:95], v[148:151], a[84:87], v[92:95]
ds_read_b64_tr_b16 v[144:145], v59 offset:32768
v_mfma_f32_16x16x32_bf16 v[96:99], v[148:151], a[148:151], v[96:99]
v_mfma_f32_16x16x32_bf16 v[100:103], v[148:151], a[212:215], v[100:103]
ds_read_b64_tr_b16 v[146:147], v59 offset:33280
v_mfma_f32_16x16x32_bf16 v[184:187], v[148:151], v[28:31], v[184:187]
s_waitcnt lgkmcnt(4)
v_mfma_f32_16x16x32_bf16 v[88:91], v[152:155], a[24:27], v[88:91]
v_mfma_f32_16x16x32_bf16 v[92:95], v[152:155], a[88:91], v[92:95]
ds_read_b64_tr_b16 v[148:149], v59 offset:36864
v_mfma_f32_16x16x32_bf16 v[96:99], v[152:155], a[152:155], v[96:99]
v_mfma_f32_16x16x32_bf16 v[100:103], v[152:155], a[216:219], v[100:103]
ds_read_b64_tr_b16 v[150:151], v59 offset:37376
v_mfma_f32_16x16x32_bf16 v[184:187], v[152:155], v[28:31], v[184:187]
s_waitcnt lgkmcnt(4)
v_mfma_f32_16x16x32_bf16 v[88:91], v[156:159], a[28:31], v[88:91]
s_waitcnt vmcnt(1)
s_mov_b64 exec, 0xffff
s_mov_b32 s63, 1000000
v_cmp_eq_u32 vcc, 0, v84
s_cbranch_vccz L_ok0
L_poll0:
buffer_load_dword v8, v87, s[20:23], 0 offen offset:0 sc1
s_waitcnt vmcnt(0)
v_cmp_eq_u32 vcc, 0, v8
s_cbranch_vccz L_ok0
s_sub_u32 s63, s63, 1
s_cbranch_scc0 L_poll0
L_ok0:
s_mov_b64 exec, -1
s_mov_b32 exec_lo, 0x00010001
s_mov_b32 exec_hi, 0
buffer_store_dwordx4 v[132:135], v76, s[16:19], s58 offen sc1
s_mov_b64 exec, -1
v_mfma_f32_16x16x32_bf16 v[92:95], v[156:159], a[92:95], v[92:95]
ds_read_b64_tr_b16 v[152:153], v59 offset:40960
v_mfma_f32_16x16x32_bf16 v[96:99], v[156:159], a[156:159], v[96:99]
v_mfma_f32_16x16x32_bf16 v[100:103], v[156:159], a[220:223], v[100:103]
buffer_load_dwordx4 v[20:23], v9, s[8:11], s49 offen offset:0
ds_read_b64_tr_b16 v[154:155], v59 offset:41472
v_mfma_f32_16x16x32_bf16 v[184:187], v[156:159], v[28:31], v[184:187]
s_waitcnt lgkmcnt(4)
v_mfma_f32_16x16x32_bf16 v[88:91], v[144:147], a[32:35], v[88:91]
v_mfma_f32_16x16x32_bf16 v[92:95], v[144:147], a[96:99], v[92:95]
ds_read_b64_tr_b16 v[156:157], v59 offset:45056
v_mfma_f32_16x16x32_bf16 v[96:99], v[144:147], a[160:163], v[96:99]
v_mfma_f32_16x16x32_bf16 v[100:103], v[144:147], a[224:227], v[100:103]
ds_read_b64_tr_b16 v[158:159], v59 offset:45568
v_mfma_f32_16x16x32_bf16 v[184:187], v[144:147], v[28:31], v[184:187]
s_waitcnt lgkmcnt(4)
v_mfma_f32_16x16x32_bf16 v[88:91], v[148:151], a[36:39], v[88:91]
buffer_load_dwordx4 v[24:27], v9, s[8:11], s49 offen offset:64
v_mfma_f32_16x16x32_bf16 v[92:95], v[148:151], a[100:103], v[92:95]
ds_read_b64_tr_b16 v[144:145], v59 offset:49152
v_mfma_f32_16x16x32_bf16 v[96:99], v[148:151], a[164:167], v[96:99]
v_mfma_f32_16x16x32_bf16 v[100:103], v[148:151], a[228:231], v[100:103]
ds_read_b64_tr_b16 v[146:147], v59 offset:49664
v_mfma_f32_16x16x32_bf16 v[184:187], v[148:151], v[28:31], v[184:187]
s_waitcnt lgkmcnt(4)
v_mfma_f32_16x16x32_bf16 v[88:91], v[152:155], a[40:43], v[88:91]
v_mfma_f32_16x16x32_bf16 v[92:95], v[152:155], a[104:107], v[92:95]
s_xor_b32 s44, s50, 0x0
s_add_u32 m0, s48, -8192
ds_read_b64_tr_b16 v[148:149], v59 offset:53248
v_mfma_f32_16x16x32_bf16 v[96:99], v[152:155], a[168:171], v[96:99]
buffer_load_dwordx4 v60, s[24:27], s44 offen offset:0 lds
v_mfma_f32_16x16x32_bf16 v[100:103], v[152:155], a[232:235], v[100:103]
ds_read_b64_tr_b16 v[150:151], v59 offset:53760
v_mfma_f32_16x16x32_bf16 v[184:187], v[152:155], v[28:31], v[184:187]
s_waitcnt lgkmcnt(4)
v_mfma_f32_16x16x32_bf16 v[88:91], v[156:159], a[44:47], v[88:91]
v_mfma_f32_16x16x32_bf16 v[92:95], v[156:159], a[108:111], v[92:95]
ds_read_b64_tr_b16 v[152:153], v59 offset:57344
v_mfma_f32_16x16x32_bf16 v[96:99], v[156:159], a[172:175], v[96:99]
v_mfma_f32_16x16x32_bf16 v[100:103], v[156:159], a[236:239], v[100:103]
ds_read_b64_tr_b16 v[154:155], v59 offset:57856
v_mfma_f32_16x16x32_bf16 v[184:187], v[156:159], v[28:31], v[184:187]
buffer_load_dwordx4 v61, s[24:27], s44 offen offset:1024 lds
s_waitcnt lgkmcnt(4)
v_mfma_f32_16x16x32_bf16 v[88:91], v[144:147], a[48:51], v[88:91]
v_mfma_f32_16x16x32_bf16 v[92:95], v[144:147], a[112:115], v[92:95]
ds_read_b64_tr_b16 v[156:157], v59 offset:61440
v_mfma_f32_16x16x32_bf16 v[96:99], v[144:147], a[176:179], v[96:99]
v_mfma_f32_16x16x32_bf16 v[100:103], v[144:147], a[240:243], v[100:103]
ds_read_b64_tr_b16 v[158:159], v59 offset:61952
v_mfma_f32_16x16x32_bf16 v[184:187], v[144:147], v[28:31], v[184:187]
s_waitcnt lgkmcnt(4)
v_mfma_f32_16x16x32_bf16 v[88:91], v[148:151], a[52:55], v[88:91]
v_mfma_f32_16x16x32_bf16 v[92:95], v[148:151], a[116:119], v[92:95]
buffer_load_dwordx4 v62, s[24:27], s44 offen offset:2048 lds
v_mfma_f32_16x16x32_bf16 v[96:99], v[148:151], a[180:183], v[96:99]
v_mfma_f32_16x16x32_bf16 v[100:103], v[148:151], a[244:247], v[100:103]
v_mfma_f32_16x16x32_bf16 v[184:187], v[148:151], v[28:31], v[184:187]
s_waitcnt lgkmcnt(2)
v_mfma_f32_16x16x32_bf16 v[88:91], v[152:155], a[56:59], v[88:91]
v_mfma_f32_16x16x32_bf16 v[92:95], v[152:155], a[120:123], v[92:95]
v_mfma_f32_16x16x32_bf16 v[96:99], v[152:155], a[184:187], v[96:99]
v_mfma_f32_16x16x32_bf16 v[100:103], v[152:155], a[248:251], v[100:103]
buffer_load_dwordx4 v63, s[24:27], s44 offen offset:3072 lds
v_mfma_f32_16x16x32_bf16 v[184:187], v[152:155], v[28:31], v[184:187]
s_waitcnt lgkmcnt(0)
v_mfma_f32_16x16x32_bf16 v[88:91], v[156:159], a[60:63], v[88:91]
v_mfma_f32_16x16x32_bf16 v[92:95], v[156:159], a[124:127], v[92:95]
v_mfma_f32_16x16x32_bf16 v[96:99], v[156:159], a[188:191], v[96:99]
v_mfma_f32_16x16x32_bf16 v[100:103], v[156:159], a[252:255], v[100:103]
v_mfma_f32_16x16x32_bf16 v[184:187], v[156:159], v[28:31], v[184:187]
s_nop 7
v_pk_fma_f32 v[88:89], v[184:185], v[192:193], v[88:89] op_sel_hi:[1,0,1]
v_pk_mul_f32 v[88:89], v[88:89], v[192:193] op_sel:[0,1] op_sel_hi:[1,1]
v_exp_f32_e64 v200, v88 clamp
v_exp_f32_e64 v201, v89 clamp
v_pk_fma_f32 v[104:105], v[88:89], v[78:79], v[78:79] op_sel:[0,0,1] op_sel_hi:[1,0,1]
v_pk_add_f32 v[200:201], v[200:201], v[80:81]
v_max_f32 v104, v104, v200
v_max_f32 v105, v105, v201
v_cvt_pk_bf16_f32 v160, v104, v105
v_pk_fma_f32 v[90:91], v[186:187], v[192:193], v[90:91] op_sel_hi:[1,0,1]
v_pk_mul_f32 v[90:91], v[90:91], v[192:193] op_sel:[0,1] op_sel_hi:[1,1]
v_exp_f32_e64 v204, v90 clamp
v_exp_f32_e64 v205, v91 clamp
v_pk_fma_f32 v[106:107], v[90:91], v[78:79], v[78:79] op_sel:[0,0,1] op_sel_hi:[1,0,1]
v_pk_add_f32 v[204:205], v[204:205], v[80:81]
v_max_f32 v106, v106, v204
v_max_f32 v107, v107, v205
v_cvt_pk_bf16_f32 v161, v106, v107
v_pk_fma_f32 v[92:93], v[184:185], v[194:195], v[92:93] op_sel_hi:[1,0,1]
v_pk_mul_f32 v[92:93], v[92:93], v[194:195] op_sel:[0,1] op_sel_hi:[1,1]
v_exp_f32_e64 v200, v92 clamp
v_exp_f32_e64 v201, v93 clamp
v_pk_fma_f32 v[108:109], v[92:93], v[78:79], v[78:79] op_sel:[0,0,1] op_sel_hi:[1,0,1]
v_pk_add_f32 v[200:201], v[200:201], v[80:81]
v_max_f32 v108, v108, v200
v_max_f32 v109, v109, v201
v_cvt_pk_bf16_f32 v162, v108, v109
v_pk_fma_f32 v[94:95], v[186:187], v[194:195], v[94:95] op_sel_hi:[1,0,1]
v_pk_mul_f32 v[94:95], v[94:95], v[194:195] op_sel:[0,1] op_sel_hi:[1,1]
v_exp_f32_e64 v204, v94 clamp
v_exp_f32_e64 v205, v95 clamp
v_pk_fma_f32 v[110:111], v[94:95], v[78:79], v[78:79] op_sel:[0,0,1] op_sel_hi:[1,0,1]
v_pk_add_f32 v[204:205], v[204:205], v[80:81]
v_max_f32 v110, v110, v204
v_max_f32 v111, v111, v205
v_cvt_pk_bf16_f32 v163, v110, v111
v_pk_fma_f32 v[96:97], v[184:185], v[196:197], v[96:97] op_sel_hi:[1,0,1]
v_pk_mul_f32 v[96:97], v[96:97], v[196:197] op_sel:[0,1] op_sel_hi:[1,1]
v_exp_f32_e64 v200, v96 clamp
v_exp_f32_e64 v201, v97 clamp
v_pk_fma_f32 v[112:113], v[96:97], v[78:79], v[78:79] op_sel:[0,0,1] op_sel_hi:[1,0,1]
v_pk_add_f32 v[200:201], v[200:201], v[80:81]
v_max_f32 v112, v112, v200
v_max_f32 v113, v113, v201
v_cvt_pk_bf16_f32 v164, v112, v113
v_pk_fma_f32 v[98:99], v[186:187], v[196:197], v[98:99] op_sel_hi:[1,0,1]
v_pk_mul_f32 v[98:99], v[98:99], v[196:197] op_sel:[0,1] op_sel_hi:[1,1]
v_exp_f32_e64 v204, v98 clamp
v_exp_f32_e64 v205, v99 clamp
v_pk_fma_f32 v[114:115], v[98:99], v[78:79], v[78:79] op_sel:[0,0,1] op_sel_hi:[1,0,1]
v_pk_add_f32 v[204:205], v[204:205], v[80:81]
v_max_f32 v114, v114, v204
v_max_f32 v115, v115, v205
v_cvt_pk_bf16_f32 v165, v114, v115
v_pk_fma_f32 v[100:101], v[184:185], v[198:199], v[100:101] op_sel_hi:[1,0,1]
v_pk_mul_f32 v[100:101], v[100:101], v[198:199] op_sel:[0,1] op_sel_hi:[1,1]
v_exp_f32_e64 v200, v100 clamp
v_exp_f32_e64 v201, v101 clamp
v_pk_fma_f32 v[116:117], v[100:101], v[78:79], v[78:79] op_sel:[0,0,1] op_sel_hi:[1,0,1]
v_pk_add_f32 v[200:201], v[200:201], v[80:81]
v_max_f32 v116, v116, v200
v_max_f32 v117, v117, v201
v_cvt_pk_bf16_f32 v166, v116, v117
v_pk_fma_f32 v[102:103], v[186:187], v[198:199], v[102:103] op_sel_hi:[1,0,1]
v_pk_mul_f32 v[102:103], v[102:103], v[198:199] op_sel:[0,1] op_sel_hi:[1,1]
v_exp_f32_e64 v204, v102 clamp
v_exp_f32_e64 v205, v103 clamp
v_pk_fma_f32 v[118:119], v[102:103], v[78:79], v[78:79] op_sel:[0,0,1] op_sel_hi:[1,0,1]
v_pk_add_f32 v[204:205], v[204:205], v[80:81]
v_max_f32 v118, v118, v204
v_max_f32 v119, v119, v205
v_cvt_pk_bf16_f32 v167, v118, v119
buffer_load_dwordx4 v[232:235], v77, s[16:19], s98 offen offset:0 sc1
s_xor_b32 s44, s50, 0x20000
s_add_u32 m0, s48, 8192
s_nop 0
buffer_load_dwordx4 v60, s[24:27], s44 offen offset:0 lds
buffer_load_dwordx4 v61, s[24:27], s44 offen offset:1024 lds
buffer_load_dwordx4 v62, s[24:27], s44 offen offset:2048 lds
buffer_load_dwordx4 v63, s[24:27], s44 offen offset:3072 lds
s_xor_b32 s44, s50, 0x40000
s_add_u32 m0, s48, 24576
s_nop 0
buffer_load_dwordx4 v60, s[24:27], s44 offen offset:0 lds
buffer_load_dwordx4 v61, s[24:27], s44 offen offset:1024 lds
buffer_load_dwordx4 v62, s[24:27], s44 offen offset:2048 lds
buffer_load_dwordx4 v63, s[24:27], s44 offen offset:3072 lds
s_lshl_b32 s57, s56, 14
s_lshl_b32 s59, s4, 16
s_lshl_b32 s7, s56, 9
s_add_u32 s59, s59, s7
s_add_u32 s59, s59, 0x100000
s_waitcnt vmcnt(8)
s_mov_b32 s63, 1000000
v_cmp_eq_u32 vcc, 0, v232
s_cbranch_vccz L_ok1
L_poll1:
buffer_load_dwordx4 v[232:235], v77, s[16:19], s98 offen offset:0 sc1
s_waitcnt vmcnt(0)
v_cmp_eq_u32 vcc, 0, v232
s_cbranch_vccz L_ok1
s_sub_u32 s63, s63, 1
s_cbranch_scc0 L_poll1
L_ok1:
buffer_load_dwordx4 v[168:171], v5, s[16:19], s57 offen offset:0 sc1
buffer_load_dwordx4 v[172:175], v5, s[16:19], s57 offen offset:1024 sc1
v_mfma_f32_16x16x32_bf16 v[124:127], v[72:75], v[232:235], 0
s_nop 7
v_add_f32_dpp v124, v124, v124 row_ror:8 row_mask:0xf bank_mask:0xf
v_add_f32_dpp v125, v125, v125 row_ror:8 row_mask:0xf bank_mask:0xf
v_add_f32_dpp v126, v126, v126 row_ror:8 row_mask:0xf bank_mask:0xf
v_add_f32_dpp v127, v127, v127 row_ror:8 row_mask:0xf bank_mask:0xf
v_add_f32_dpp v124, v124, v124 row_ror:4 row_mask:0xf bank_mask:0xf
v_add_f32_dpp v125, v125, v125 row_ror:4 row_mask:0xf bank_mask:0xf
v_add_f32_dpp v126, v126, v126 row_ror:4 row_mask:0xf bank_mask:0xf
buffer_load_dwordx4 v[176:179], v5, s[16:19], s57 offen offset:2048 sc1
v_add_f32_dpp v127, v127, v127 row_ror:4 row_mask:0xf bank_mask:0xf
v_add_f32_dpp v124, v124, v124 row_ror:2 row_mask:0xf bank_mask:0xf
v_add_f32_dpp v125, v125, v125 row_ror:2 row_mask:0xf bank_mask:0xf
v_add_f32_dpp v126, v126, v126 row_ror:2 row_mask:0xf bank_mask:0xf
v_add_f32_dpp v127, v127, v127 row_ror:2 row_mask:0xf bank_mask:0xf
v_add_f32_dpp v124, v124, v124 row_ror:1 row_mask:0xf bank_mask:0xf
v_add_f32_dpp v125, v125, v125 row_ror:1 row_mask:0xf bank_mask:0xf
v_add_f32_dpp v126, v126, v126 row_ror:1 row_mask:0xf bank_mask:0xf
buffer_load_dwordx4 v[180:183], v5, s[16:19], s57 offen offset:3072 sc1
s_add_u32 s57, s57, 4096
v_add_f32_dpp v127, v127, v127 row_ror:1 row_mask:0xf bank_mask:0xf
v_cvt_pk_bf16_f32 v130, v124, v125
v_cvt_pk_bf16_f32 v131, v126, v127
s_nop 1
v_mfma_f32_16x16x16_bf16 v[144:147], v[130:131], v[160:161], v[80:83]
v_mfma_f32_16x16x16_bf16 v[148:151], v[130:131], v[162:163], v[80:83]
v_mfma_f32_16x16x16_bf16 v[152:155], v[130:131], v[164:165], v[80:83]
v_mfma_f32_16x16x16_bf16 v[156:159], v[130:131], v[166:167], v[80:83]
s_nop 4
v_rcp_f32 v144, v144
buffer_load_dwordx4 v[184:187], v5, s[16:19], s57 offen offset:0 sc1
v_rcp_f32 v148, v148
v_rcp_f32 v152, v152
v_rcp_f32 v156, v156
v_mul_f32 v144, v78, v144
v_mul_f32 v148, v78, v148
v_mul_f32 v152, v78, v152
v_mul_f32 v156, v78, v156
v_pk_mul_f32 v[104:105], v[104:105], v[144:145] op_sel_hi:[1,0]
buffer_load_dwordx4 v[188:191], v5, s[16:19], s57 offen offset:1024 sc1
v_pk_mul_f32 v[106:107], v[106:107], v[144:145] op_sel_hi:[1,0]
v_pk_mul_f32 v[108:109], v[108:109], v[148:149] op_sel_hi:[1,0]
v_pk_mul_f32 v[110:111], v[110:111], v[148:149] op_sel_hi:[1,0]
v_pk_mul_f32 v[112:113], v[112:113], v[152:153] op_sel_hi:[1,0]
v_pk_mul_f32 v[114:115], v[114:115], v[152:153] op_sel_hi:[1,0]
v_pk_mul_f32 v[116:117], v[116:117], v[156:157] op_sel_hi:[1,0]
v_pk_mul_f32 v[118:119], v[118:119], v[156:157] op_sel_hi:[1,0]
v_cvt_pk_bf16_f32 v160, v104, v105
buffer_load_dwordx4 v[192:195], v5, s[16:19], s57 offen offset:2048 sc1
v_cvt_pk_bf16_f32 v161, v106, v107
v_cvt_pk_bf16_f32 v162, v108, v109
v_cvt_pk_bf16_f32 v163, v110, v111
v_cvt_pk_bf16_f32 v164, v112, v113
v_cvt_pk_bf16_f32 v165, v114, v115
v_cvt_pk_bf16_f32 v166, v116, v117
v_cvt_pk_bf16_f32 v167, v118, v119
buffer_load_dwordx4 v[196:199], v5, s[16:19], s57 offen offset:3072 sc1
s_add_u32 s57, s57, 4096
s_barrier
buffer_load_dwordx4 v[200:203], v5, s[16:19], s57 offen offset:0 sc1
buffer_load_dwordx4 v[204:207], v5, s[16:19], s57 offen offset:1024 sc1
buffer_load_dwordx4 v[208:211], v5, s[16:19], s57 offen offset:2048 sc1
buffer_load_dwordx4 v[212:215], v5, s[16:19], s57 offen offset:3072 sc1
s_add_u32 s57, s57, 4096
buffer_load_dwordx4 v[216:219], v5, s[16:19], s57 offen offset:0 sc1
buffer_load_dwordx4 v[220:223], v5, s[16:19], s57 offen offset:1024 sc1
buffer_load_dwordx4 v[224:227], v5, s[16:19], s57 offen offset:2048 sc1
buffer_load_dwordx4 v[228:231], v5, s[16:19], s57 offen offset:3072 sc1
s_xor_b32 s44, s50, 0x60000
s_add_u32 m0, s48, 40960
s_nop 0
buffer_load_dwordx4 v60, s[24:27], s44 offen offset:0 lds
buffer_load_dwordx4 v61, s[24:27], s44 offen offset:1024 lds
buffer_load_dwordx4 v62, s[24:27], s44 offen offset:2048 lds
buffer_load_dwordx4 v63, s[24:27], s44 offen offset:3072 lds
s_waitcnt vmcnt(19)
v_mfma_f32_16x16x32_bf16 v[120:123], v[72:75], v[168:171], 0
s_waitcnt vmcnt(18)
v_mfma_f32_16x16x32_bf16 v[120:123], v[72:75], v[172:175], v[120:123]
s_waitcnt vmcnt(17)
v_mfma_f32_16x16x32_bf16 v[120:123], v[72:75], v[176:179], v[120:123]
s_waitcnt vmcnt(16)
v_mfma_f32_16x16x32_bf16 v[120:123], v[72:75], v[180:183], v[120:123]
s_waitcnt vmcnt(15)
v_mfma_f32_16x16x32_bf16 v[120:123], v[72:75], v[184:187], v[120:123]
s_waitcnt vmcnt(14)
v_mfma_f32_16x16x32_bf16 v[120:123], v[72:75], v[188:191], v[120:123]
s_waitcnt vmcnt(13)
v_mfma_f32_16x16x32_bf16 v[120:123], v[72:75], v[192:195], v[120:123]
s_waitcnt vmcnt(12)
v_mfma_f32_16x16x32_bf16 v[120:123], v[72:75], v[196:199], v[120:123]
s_waitcnt vmcnt(11)
v_mfma_f32_16x16x32_bf16 v[120:123], v[72:75], v[200:203], v[120:123]
s_waitcnt vmcnt(10)
v_mfma_f32_16x16x32_bf16 v[120:123], v[72:75], v[204:207], v[120:123]
s_waitcnt vmcnt(9)
v_mfma_f32_16x16x32_bf16 v[120:123], v[72:75], v[208:211], v[120:123]
s_waitcnt vmcnt(8)
v_mfma_f32_16x16x32_bf16 v[120:123], v[72:75], v[212:215], v[120:123]
s_waitcnt vmcnt(7)
v_mfma_f32_16x16x32_bf16 v[120:123], v[72:75], v[216:219], v[120:123]
s_waitcnt vmcnt(6)
v_mfma_f32_16x16x32_bf16 v[120:123], v[72:75], v[220:223], v[120:123]
s_waitcnt vmcnt(5)
v_mfma_f32_16x16x32_bf16 v[120:123], v[72:75], v[224:227], v[120:123]
s_waitcnt vmcnt(4)
v_mfma_f32_16x16x32_bf16 v[120:123], v[72:75], v[228:231], v[120:123]
s_nop 7
v_cvt_pk_bf16_f32 v128, v120, v121
v_cvt_pk_bf16_f32 v129, v122, v123
s_nop 1
v_mfma_f32_16x16x16_bf16 v[88:91], v[128:129], v[160:161], 0
v_mfma_f32_16x16x16_bf16 v[92:95], v[128:129], v[162:163], 0
v_mfma_f32_16x16x16_bf16 v[96:99], v[128:129], v[164:165], 0
v_mfma_f32_16x16x16_bf16 v[100:103], v[128:129], v[166:167], 0
s_nop 4
v_cvt_pk_bf16_f32 v136, v88, v89
v_cvt_pk_bf16_f32 v137, v90, v91
v_cvt_pk_bf16_f32 v138, v92, v93
v_cvt_pk_bf16_f32 v139, v94, v95
s_nop 0
v_permlane16_swap_b32 v136, v138
v_permlane16_swap_b32 v137, v139
buffer_store_dwordx4 v[136:139], v68, s[16:19], s59 offen sc1
v_cvt_pk_bf16_f32 v140, v96, v97
v_cvt_pk_bf16_f32 v141, v98, v99
v_cvt_pk_bf16_f32 v142, v100, v101
v_cvt_pk_bf16_f32 v143, v102, v103
s_nop 0
v_permlane16_swap_b32 v140, v142
v_permlane16_swap_b32 v141, v143
buffer_store_dwordx4 v[140:143], v69, s[16:19], s59 offen sc1
s_add_u32 m0, s47, 131072
s_waitcnt vmcnt(35)
buffer_load_dwordx4 v32, s[28:31], s64 offen lds
v_permlane16_swap_b32 v20, v22
v_permlane16_swap_b32 v21, v23
v_permlane16_swap_b32 v24, v26
v_permlane16_swap_b32 v25, v27
v_lshlrev_b32 v112, 16, v20
v_and_b32 v113, 0xffff0000, v20
v_lshlrev_b32 v114, 16, v21
v_and_b32 v115, 0xffff0000, v21
v_lshlrev_b32 v116, 16, v22
s_add_u32 m0, s47, 135168
v_and_b32 v117, 0xffff0000, v22
buffer_load_dwordx4 v33, s[28:31], s64 offen lds
v_lshlrev_b32 v118, 16, v23
v_and_b32 v119, 0xffff0000, v23
v_lshlrev_b32 v120, 16, v24
v_and_b32 v121, 0xffff0000, v24
v_lshlrev_b32 v122, 16, v25
v_and_b32 v123, 0xffff0000, v25
v_lshlrev_b32 v124, 16, v26
v_and_b32 v125, 0xffff0000, v26
v_lshlrev_b32 v126, 16, v27
s_add_u32 m0, s47, 139264
v_and_b32 v127, 0xffff0000, v27
buffer_load_dwordx4 v34, s[28:31], s64 offen lds
s_lshl_b32 s55, s51, 2
s_add_u32 s55, s55, s1
s_lshl_b32 s59, s55, 2
s_add_u32 s59, s59, s6
s_lshl_b32 s59, s59, 12
s_add_u32 s59, s59, 0x100000
s_xor_b32 s60, s59, 0x1000
s_xor_b32 s61, s59, 0x2000
s_xor_b32 s62, s59, 0x3000
v_bfe_u32 v4, v0, 4, 2
v_lshlrev_b32 v4, 3, v4
s_waitcnt vmcnt(3)
s_mov_b64 exec, 1
buffer_store_dword v7, off, s[16:19], s58 offset:64 sc1
s_mov_b64 exec, -1
s_lshl_b32 s48, s3, 13
buffer_load_dword v40, v39, s[32:35], 0 offen
s_lshl_b32 s96, s3, 15
s_cmp_eq_u32 s3, 3
s_cselect_b32 s96, 0x20000, s96
s_add_u32 s96, s96, 28672
s_sub_u32 s7, s96, s48
s_add_u32 s7, s7, -65536
v_add_u32 v56, s7, v14
v_add_u32 v57, s7, v15
v_add_u32 v58, s7, v16
v_add_u32 v59, s7, v17
s_add_u32 s48, s48, 98304
s_mul_i32 s63, s3, 458752
s_lshl_b32 s7, s52, 7
s_add_u32 s63, s63, s7
s_xor_b32 s7, s6, 0
s_mul_i32 s7, s7, 114688
s_add_u32 s68, s7, s63
s_xor_b32 s7, s6, 1
s_mul_i32 s7, s7, 114688
s_add_u32 s69, s7, s63
s_xor_b32 s7, s6, 2
s_add_u32 m0, s47, 143360
s_mul_i32 s7, s7, 114688
buffer_load_dwordx4 v35, s[28:31], s64 offen lds
s_add_u32 s70, s7, s63
s_xor_b32 s7, s6, 3
s_mul_i32 s7, s7, 114688
s_add_u32 s71, s7, s63
v_bfe_u32 v1, v0, 2, 4
v_mul_u32_u24 v1, 224, v1
v_and_b32 v2, 3, v0
v_lshl_add_u32 v42, v2, 3, v1
v_add_u32 v43, 0x10000, v42
v_add_u32 v44, 0x20000, v42
s_lshl_b32 s7, s3, 5
s_add_u32 s63, s7, 128
s_cmp_eq_u32 s3, 3
s_cselect_b32 s63, s7, s63
v_add_u32 v46, s7, v42
v_add_u32 v47, s63, v42
v_add_u32 v48, s7, v43
v_add_u32 v49, s63, v43
v_add_u32 v50, s7, v44
v_add_u32 v51, s63, v44
v_lshl_add_u32 v55, v4, 1, s96
s_add_u32 m0, s47, 147456
v_add_u32 v55, s7, v55
buffer_load_dwordx4 v36, s[28:31], s64 offen lds
v_add_u32 v1, 1, v2
v_lshrrev_b32 v1, 2, v1
v_add_u32 v1, v1, v2
s_lshl_b32 s7, s3, 6
s_add_u32 s7, s7, 28672
v_lshl_add_u32 v1, v1, 15, s7
v_lshl_add_u32 v54, v4, 1, v1
v_lshl_add_u32 v54, v2, 5, v54
v_and_b32 v1, 15, v0
v_lshlrev_b32 v2, 5, v4
v_lshl_add_u32 v52, v1, 3, v2
v_add_u32 v53, 16384, v5
s_lshl_b32 s7, s55, 3
s_add_u32 s7, s7, s52
s_lshl_b32 s56, s7, 11
s_add_u32 s56, s56, 0x400000
s_lshl_b32 s7, s7, 7
s_add_u32 s57, s7, 0x600000
s_lshl_b32 s7, s51, 7
s_add_u32 s7, s7, 0x700000
s_add_u32 m0, s47, 151552
v_lshlrev_b32 v3, 5, v6
buffer_load_dwordx4 v37, s[28:31], s64 offen lds
s_waitcnt vmcnt(10)
s_barrier
ds_read_b64_tr_b16 a[0:1], v64 offset:0
ds_read_b64_tr_b16 a[2:3], v64 offset:512
ds_read_b64_tr_b16 a[4:5], v65 offset:0
ds_read_b64_tr_b16 a[6:7], v65 offset:512
ds_read_b64_tr_b16 a[8:9], v66 offset:0
ds_read_b64_tr_b16 a[10:11], v66 offset:512
ds_read_b64_tr_b16 a[12:13], v67 offset:0
ds_read_b64_tr_b16 a[14:15], v67 offset:512
ds_read_b64_tr_b16 a[16:17], v64 offset:4096
ds_read_b64_tr_b16 a[18:19], v64 offset:4608
ds_read_b64_tr_b16 a[20:21], v65 offset:4096
ds_read_b64_tr_b16 a[22:23], v65 offset:4608
ds_read_b64_tr_b16 a[24:25], v66 offset:4096
ds_read_b64_tr_b16 a[26:27], v66 offset:4608
ds_read_b64_tr_b16 a[28:29], v67 offset:4096
ds_read_b64_tr_b16 a[30:31], v67 offset:4608
ds_read_b64_tr_b16 a[32:33], v64 offset:8192
ds_read_b64_tr_b16 a[34:35], v64 offset:8704
ds_read_b64_tr_b16 a[36:37], v65 offset:8192
s_add_u32 m0, s47, 155648
ds_read_b64_tr_b16 a[38:39], v65 offset:8704
buffer_load_dwordx4 v38, s[28:31], s64 offen lds
ds_read_b64_tr_b16 a[40:41], v66 offset:8192
ds_read_b64_tr_b16 a[42:43], v66 offset:8704
ds_read_b64_tr_b16 a[44:45], v67 offset:8192
ds_read_b64_tr_b16 a[46:47], v67 offset:8704
ds_read_b64_tr_b16 a[48:49], v64 offset:12288
ds_read_b64_tr_b16 a[50:51], v64 offset:12800
ds_read_b64_tr_b16 a[52:53], v65 offset:12288
ds_read_b64_tr_b16 a[54:55], v65 offset:12800
ds_read_b64_tr_b16 a[56:57], v66 offset:12288
ds_read_b64_tr_b16 a[58:59], v66 offset:12800
ds_read_b64_tr_b16 a[60:61], v67 offset:12288
ds_read_b64_tr_b16 a[62:63], v67 offset:12800
ds_read_b64_tr_b16 a[64:65], v64 offset:16384
ds_read_b64_tr_b16 a[66:67], v64 offset:16896
ds_read_b64_tr_b16 a[68:69], v65 offset:16384
ds_read_b64_tr_b16 a[70:71], v65 offset:16896
ds_read_b64_tr_b16 a[72:73], v66 offset:16384
ds_read_b64_tr_b16 a[74:75], v66 offset:16896
ds_read_b64_tr_b16 a[76:77], v67 offset:16384
ds_read_b64_tr_b16 a[78:79], v67 offset:16896
s_add_u32 m0, s47, 0
ds_read_b64_tr_b16 a[80:81], v64 offset:20480
buffer_load_dwordx4 v32, s[28:31], s65 offen lds
ds_read_b64_tr_b16 a[82:83], v64 offset:20992
ds_read_b64_tr_b16 a[84:85], v65 offset:20480
ds_read_b64_tr_b16 a[86:87], v65 offset:20992
ds_read_b64_tr_b16 a[88:89], v66 offset:20480
ds_read_b64_tr_b16 a[90:91], v66 offset:20992
ds_read_b64_tr_b16 a[92:93], v67 offset:20480
ds_read_b64_tr_b16 a[94:95], v67 offset:20992
ds_read_b64_tr_b16 a[96:97], v64 offset:24576
ds_read_b64_tr_b16 a[98:99], v64 offset:25088
ds_read_b64_tr_b16 a[100:101], v65 offset:24576
ds_read_b64_tr_b16 a[102:103], v65 offset:25088
ds_read_b64_tr_b16 a[104:105], v66 offset:24576
ds_read_b64_tr_b16 a[106:107], v66 offset:25088
ds_read_b64_tr_b16 a[108:109], v67 offset:24576
ds_read_b64_tr_b16 a[110:111], v67 offset:25088
ds_read_b64_tr_b16 a[112:113], v64 offset:28672
ds_read_b64_tr_b16 a[114:115], v64 offset:29184
ds_read_b64_tr_b16 a[116:117], v65 offset:28672
ds_read_b64_tr_b16 a[118:119], v65 offset:29184
ds_read_b64_tr_b16 a[120:121], v66 offset:28672
s_add_u32 m0, s47, 4096
ds_read_b64_tr_b16 a[122:123], v66 offset:29184
buffer_load_dwordx4 v33, s[28:31], s65 offen lds
ds_read_b64_tr_b16 a[124:125], v67 offset:28672
ds_read_b64_tr_b16 a[126:127], v67 offset:29184
ds_read_b64_tr_b16 a[128:129], v64 offset:32768
ds_read_b64_tr_b16 a[130:131], v64 offset:33280
ds_read_b64_tr_b16 a[132:133], v65 offset:32768
ds_read_b64_tr_b16 a[134:135], v65 offset:33280
ds_read_b64_tr_b16 a[136:137], v66 offset:32768
ds_read_b64_tr_b16 a[138:139], v66 offset:33280
ds_read_b64_tr_b16 a[140:141], v67 offset:32768
ds_read_b64_tr_b16 a[142:143], v67 offset:33280
ds_read_b64_tr_b16 a[144:145], v64 offset:36864
ds_read_b64_tr_b16 a[146:147], v64 offset:37376
ds_read_b64_tr_b16 a[148:149], v65 offset:36864
ds_read_b64_tr_b16 a[150:151], v65 offset:37376
ds_read_b64_tr_b16 a[152:153], v66 offset:36864
ds_read_b64_tr_b16 a[154:155], v66 offset:37376
ds_read_b64_tr_b16 a[156:157], v67 offset:36864
ds_read_b64_tr_b16 a[158:159], v67 offset:37376
ds_read_b64_tr_b16 a[160:161], v64 offset:40960
ds_read_b64_tr_b16 a[162:163], v64 offset:41472
s_add_u32 m0, s47, 8192
ds_read_b64_tr_b16 a[164:165], v65 offset:40960
buffer_load_dwordx4 v34, s[28:31], s65 offen lds
ds_read_b64_tr_b16 a[166:167], v65 offset:41472
ds_read_b64_tr_b16 a[168:169], v66 offset:40960
ds_read_b64_tr_b16 a[170:171], v66 offset:41472
ds_read_b64_tr_b16 a[172:173], v67 offset:40960
ds_read_b64_tr_b16 a[174:175], v67 offset:41472
ds_read_b64_tr_b16 a[176:177], v64 offset:45056
ds_read_b64_tr_b16 a[178:179], v64 offset:45568
ds_read_b64_tr_b16 a[180:181], v65 offset:45056
ds_read_b64_tr_b16 a[182:183], v65 offset:45568
ds_read_b64_tr_b16 a[184:185], v66 offset:45056
ds_read_b64_tr_b16 a[186:187], v66 offset:45568
ds_read_b64_tr_b16 a[188:189], v67 offset:45056
ds_read_b64_tr_b16 a[190:191], v67 offset:45568
ds_read_b64_tr_b16 a[192:193], v64 offset:49152
ds_read_b64_tr_b16 a[194:195], v64 offset:49664
ds_read_b64_tr_b16 a[196:197], v65 offset:49152
ds_read_b64_tr_b16 a[198:199], v65 offset:49664
ds_read_b64_tr_b16 a[200:201], v66 offset:49152
ds_read_b64_tr_b16 a[202:203], v66 offset:49664
ds_read_b64_tr_b16 a[204:205], v67 offset:49152
s_add_u32 m0, s47, 12288
ds_read_b64_tr_b16 a[206:207], v67 offset:49664
buffer_load_dwordx4 v35, s[28:31], s65 offen lds
ds_read_b64_tr_b16 a[208:209], v64 offset:53248
ds_read_b64_tr_b16 a[210:211], v64 offset:53760
ds_read_b64_tr_b16 a[212:213], v65 offset:53248
ds_read_b64_tr_b16 a[214:215], v65 offset:53760
ds_read_b64_tr_b16 a[216:217], v66 offset:53248
ds_read_b64_tr_b16 a[218:219], v66 offset:53760
ds_read_b64_tr_b16 a[220:221], v67 offset:53248
ds_read_b64_tr_b16 a[222:223], v67 offset:53760
ds_read_b64_tr_b16 a[224:225], v64 offset:57344
ds_read_b64_tr_b16 a[226:227], v64 offset:57856
ds_read_b64_tr_b16 a[228:229], v65 offset:57344
ds_read_b64_tr_b16 a[230:231], v65 offset:57856
ds_read_b64_tr_b16 a[232:233], v66 offset:57344
ds_read_b64_tr_b16 a[234:235], v66 offset:57856
ds_read_b64_tr_b16 a[236:237], v67 offset:57344
ds_read_b64_tr_b16 a[238:239], v67 offset:57856
ds_read_b64_tr_b16 a[240:241], v64 offset:61440
ds_read_b64_tr_b16 a[242:243], v64 offset:61952
ds_read_b64_tr_b16 a[244:245], v65 offset:61440
ds_read_b64_tr_b16 a[246:247], v65 offset:61952
ds_read_b64_tr_b16 a[248:249], v66 offset:61440
ds_read_b64_tr_b16 a[250:251], v66 offset:61952
ds_read_b64_tr_b16 a[252:253], v67 offset:61440
ds_read_b64_tr_b16 a[254:255], v67 offset:61952
s_mov_b32 exec_hi, 0
buffer_load_dword v8, v3, s[16:19], s7 offen offset:64 sc1
s_mov_b64 exec, -1
s_add_u32 m0, s47, 16384
s_nop 0
buffer_load_dwordx4 v36, s[28:31], s65 offen lds
s_add_u32 m0, s47, 20480
s_nop 0
buffer_load_dwordx4 v37, s[28:31], s65 offen lds
s_add_u32 m0, s47, 24576
s_nop 0
buffer_load_dwordx4 v38, s[28:31], s65 offen lds
buffer_load_dwordx2 v[68:69], v4, s[36:39], s46 offen offset:0
buffer_load_dwordx2 v[70:71], v4, s[36:39], s46 offen offset:32
buffer_load_dwordx2 v[72:73], v4, s[36:39], s46 offen offset:64
buffer_load_dwordx2 v[74:75], v4, s[36:39], s46 offen offset:96
buffer_load_dwordx2 v[76:77], v4, s[36:39], s46 offen offset:128
buffer_load_dwordx2 v[78:79], v4, s[36:39], s46 offen offset:160
buffer_load_dwordx2 v[80:81], v4, s[36:39], s46 offen offset:192
s_waitcnt vmcnt(10)
s_mov_b32 exec_hi, 0
s_mov_b32 s63, 1000000
v_cmp_eq_u32 vcc, 0, v8
s_cbranch_vccz L_ok2
L_poll2:
buffer_load_dword v8, v3, s[16:19], s7 offen offset:64 sc1
s_waitcnt vmcnt(0)
v_cmp_eq_u32 vcc, 0, v8
s_cbranch_vccz L_ok2
s_sub_u32 s63, s63, 1
s_cbranch_scc0 L_poll2
L_ok2:
s_mov_b64 exec, -1
buffer_load_dwordx4 v[140:143], v5, s[16:19], s59 offen offset:0 sc1
buffer_load_dwordx4 v[144:147], v5, s[16:19], s59 offen offset:1024 sc1
buffer_load_dwordx4 v[148:151], v5, s[16:19], s59 offen offset:2048 sc1
s_waitcnt vmcnt(3)
v_lshlrev_b32 v84, 16, v68
v_and_b32 v85, 0xffff0000, v68
v_lshlrev_b32 v86, 16, v69
v_and_b32 v87, 0xffff0000, v69
v_lshlrev_b32 v88, 16, v70
v_and_b32 v89, 0xffff0000, v70
buffer_load_dwordx4 v[152:155], v5, s[16:19], s59 offen offset:3072 sc1
v_lshlrev_b32 v90, 16, v71
v_and_b32 v91, 0xffff0000, v71
v_lshlrev_b32 v92, 16, v72
v_and_b32 v93, 0xffff0000, v72
v_lshlrev_b32 v94, 16, v73
v_and_b32 v95, 0xffff0000, v73
buffer_load_dwordx4 v[156:159], v5, s[16:19], s60 offen offset:0 sc1
v_lshlrev_b32 v96, 16, v74
v_and_b32 v97, 0xffff0000, v74
v_lshlrev_b32 v98, 16, v75
v_and_b32 v99, 0xffff0000, v75
v_lshlrev_b32 v100, 16, v76
v_and_b32 v101, 0xffff0000, v76
buffer_load_dwordx4 v[160:163], v5, s[16:19], s60 offen offset:1024 sc1
v_lshlrev_b32 v102, 16, v77
v_and_b32 v103, 0xffff0000, v77
v_lshlrev_b32 v104, 16, v78
v_and_b32 v105, 0xffff0000, v78
v_lshlrev_b32 v106, 16, v79
v_and_b32 v107, 0xffff0000, v79
buffer_load_dwordx4 v[164:167], v5, s[16:19], s60 offen offset:2048 sc1
v_lshlrev_b32 v108, 16, v80
v_and_b32 v109, 0xffff0000, v80
v_lshlrev_b32 v110, 16, v81
v_and_b32 v111, 0xffff0000, v81
v_lshrrev_b32 v4, 1, v5
buffer_load_dwordx4 v[168:171], v5, s[16:19], s60 offen offset:3072 sc1
buffer_load_dwordx4 v[172:175], v5, s[16:19], s61 offen offset:0 sc1
buffer_load_dwordx4 v[176:179], v5, s[16:19], s61 offen offset:1024 sc1
s_waitcnt vmcnt(17)
s_waitcnt lgkmcnt(0)
s_barrier
s_waitcnt vmcnt(9)
v_mfma_f32_16x16x32_bf16 v[112:115], a[0:3], v[140:143], v[112:115]
v_mfma_f32_16x16x32_bf16 v[116:119], a[4:7], v[140:143], v[116:119]
buffer_load_dwordx4 v[180:183], v5, s[16:19], s61 offen offset:2048 sc1
v_mfma_f32_16x16x32_bf16 v[120:123], a[8:11], v[140:143], v[120:123]
v_mfma_f32_16x16x32_bf16 v[124:127], a[12:15], v[140:143], v[124:127]
s_waitcnt vmcnt(9)
v_mfma_f32_16x16x32_bf16 v[112:115], a[16:19], v[144:147], v[112:115]
v_mfma_f32_16x16x32_bf16 v[116:119], a[20:23], v[144:147], v[116:119]
buffer_load_dwordx4 v[184:187], v5, s[16:19], s61 offen offset:3072 sc1
v_mfma_f32_16x16x32_bf16 v[120:123], a[24:27], v[144:147], v[120:123]
v_mfma_f32_16x16x32_bf16 v[124:127], a[28:31], v[144:147], v[124:127]
s_waitcnt vmcnt(9)
v_mfma_f32_16x16x32_bf16 v[112:115], a[32:35], v[148:151], v[112:115]
v_mfma_f32_16x16x32_bf16 v[116:119], a[36:39], v[148:151], v[116:119]
buffer_load_dwordx4 v[188:191], v5, s[16:19], s62 offen offset:0 sc1
v_mfma_f32_16x16x32_bf16 v[120:123], a[40:43], v[148:151], v[120:123]
v_mfma_f32_16x16x32_bf16 v[124:127], a[44:47], v[148:151], v[124:127]
s_waitcnt vmcnt(9)
v_mfma_f32_16x16x32_bf16 v[112:115], a[48:51], v[152:155], v[112:115]
v_mfma_f32_16x16x32_bf16 v[116:119], a[52:55], v[152:155], v[116:119]
buffer_load_dwordx4 v[192:195], v5, s[16:19], s62 offen offset:1024 sc1
v_mfma_f32_16x16x32_bf16 v[120:123], a[56:59], v[152:155], v[120:123]
v_mfma_f32_16x16x32_bf16 v[124:127], a[60:63], v[152:155], v[124:127]
s_waitcnt vmcnt(9)
v_mfma_f32_16x16x32_bf16 v[112:115], a[64:67], v[156:159], v[112:115]
v_mfma_f32_16x16x32_bf16 v[116:119], a[68:71], v[156:159], v[116:119]
buffer_load_dwordx4 v[196:199], v5, s[16:19], s62 offen offset:2048 sc1
v_mfma_f32_16x16x32_bf16 v[120:123], a[72:75], v[156:159], v[120:123]
v_mfma_f32_16x16x32_bf16 v[124:127], a[76:79], v[156:159], v[124:127]
s_waitcnt vmcnt(9)
v_mfma_f32_16x16x32_bf16 v[112:115], a[80:83], v[160:163], v[112:115]
v_mfma_f32_16x16x32_bf16 v[116:119], a[84:87], v[160:163], v[116:119]
buffer_load_dwordx4 v[200:203], v5, s[16:19], s62 offen offset:3072 sc1
v_mfma_f32_16x16x32_bf16 v[120:123], a[88:91], v[160:163], v[120:123]
v_mfma_f32_16x16x32_bf16 v[124:127], a[92:95], v[160:163], v[124:127]
s_waitcnt vmcnt(9)
v_mfma_f32_16x16x32_bf16 v[112:115], a[96:99], v[164:167], v[112:115]
s_add_u32 m0, s47, 32768
v_mfma_f32_16x16x32_bf16 v[116:119], a[100:103], v[164:167], v[116:119]
buffer_load_dwordx4 v32, s[28:31], s66 offen lds
v_mfma_f32_16x16x32_bf16 v[120:123], a[104:107], v[164:167], v[120:123]
v_mfma_f32_16x16x32_bf16 v[124:127], a[108:111], v[164:167], v[124:127]
s_waitcnt vmcnt(9)
v_mfma_f32_16x16x32_bf16 v[112:115], a[112:115], v[168:171], v[112:115]
s_add_u32 m0, s47, 36864
v_mfma_f32_16x16x32_bf16 v[116:119], a[116:119], v[168:171], v[116:119]
buffer_load_dwordx4 v33, s[28:31], s66 offen lds
v_mfma_f32_16x16x32_bf16 v[120:123], a[120:123], v[168:171], v[120:123]
v_mfma_f32_16x16x32_bf16 v[124:127], a[124:127], v[168:171], v[124:127]
s_waitcnt vmcnt(9)
v_mfma_f32_16x16x32_bf16 v[112:115], a[128:131], v[172:175], v[112:115]
s_add_u32 m0, s47, 40960
v_mfma_f32_16x16x32_bf16 v[116:119], a[132:135], v[172:175], v[116:119]
buffer_load_dwordx4 v34, s[28:31], s66 offen lds
v_mfma_f32_16x16x32_bf16 v[120:123], a[136:139], v[172:175], v[120:123]
v_mfma_f32_16x16x32_bf16 v[124:127], a[140:143], v[172:175], v[124:127]
s_waitcnt vmcnt(9)
v_mfma_f32_16x16x32_bf16 v[112:115], a[144:147], v[176:179], v[112:115]
s_add_u32 m0, s47, 45056
v_mfma_f32_16x16x32_bf16 v[116:119], a[148:151], v[176:179], v[116:119]
buffer_load_dwordx4 v35, s[28:31], s66 offen lds
v_mfma_f32_16x16x32_bf16 v[120:123], a[152:155], v[176:179], v[120:123]
v_mfma_f32_16x16x32_bf16 v[124:127], a[156:159], v[176:179], v[124:127]
s_waitcnt vmcnt(9)
v_mfma_f32_16x16x32_bf16 v[112:115], a[160:163], v[180:183], v[112:115]
s_add_u32 m0, s47, 49152
v_mfma_f32_16x16x32_bf16 v[116:119], a[164:167], v[180:183], v[116:119]
buffer_load_dwordx4 v36, s[28:31], s66 offen lds
v_mfma_f32_16x16x32_bf16 v[120:123], a[168:171], v[180:183], v[120:123]
v_mfma_f32_16x16x32_bf16 v[124:127], a[172:175], v[180:183], v[124:127]
s_waitcnt vmcnt(9)
v_mfma_f32_16x16x32_bf16 v[112:115], a[176:179], v[184:187], v[112:115]
s_add_u32 m0, s47, 53248
v_mfma_f32_16x16x32_bf16 v[116:119], a[180:183], v[184:187], v[116:119]
buffer_load_dwordx4 v37, s[28:31], s66 offen lds
v_mfma_f32_16x16x32_bf16 v[120:123], a[184:187], v[184:187], v[120:123]
v_mfma_f32_16x16x32_bf16 v[124:127], a[188:191], v[184:187], v[124:127]
s_waitcnt vmcnt(9)
v_mfma_f32_16x16x32_bf16 v[112:115], a[192:195], v[188:191], v[112:115]
s_add_u32 m0, s47, 57344
v_mfma_f32_16x16x32_bf16 v[116:119], a[196:199], v[188:191], v[116:119]
buffer_load_dwordx4 v38, s[28:31], s66 offen lds
v_mfma_f32_16x16x32_bf16 v[120:123], a[200:203], v[188:191], v[120:123]
v_mfma_f32_16x16x32_bf16 v[124:127], a[204:207], v[188:191], v[124:127]
s_waitcnt vmcnt(9)
v_mfma_f32_16x16x32_bf16 v[112:115], a[208:211], v[192:195], v[112:115]
v_mfma_f32_16x16x32_bf16 v[116:119], a[212:215], v[192:195], v[116:119]
v_mfma_f32_16x16x32_bf16 v[120:123], a[216:219], v[192:195], v[120:123]
v_mfma_f32_16x16x32_bf16 v[124:127], a[220:223], v[192:195], v[124:127]
s_waitcnt vmcnt(8)
v_mfma_f32_16x16x32_bf16 v[112:115], a[224:227], v[196:199], v[112:115]
v_mfma_f32_16x16x32_bf16 v[116:119], a[228:231], v[196:199], v[116:119]
v_mfma_f32_16x16x32_bf16 v[120:123], a[232:235], v[196:199], v[120:123]
v_mfma_f32_16x16x32_bf16 v[124:127], a[236:239], v[196:199], v[124:127]
s_waitcnt vmcnt(7)
v_mfma_f32_16x16x32_bf16 v[112:115], a[240:243], v[200:203], v[112:115]
v_mfma_f32_16x16x32_bf16 v[116:119], a[244:247], v[200:203], v[116:119]
v_mfma_f32_16x16x32_bf16 v[120:123], a[248:251], v[200:203], v[120:123]
v_mfma_f32_16x16x32_bf16 v[124:127], a[252:255], v[200:203], v[124:127]
s_nop 4
v_cvt_pk_bf16_f32 v20, v112, v113
v_cvt_pk_bf16_f32 v21, v114, v115
v_cvt_pk_bf16_f32 v22, v116, v117
v_cvt_pk_bf16_f32 v23, v118, v119
buffer_store_dwordx4 v[20:23], v5, s[16:19], s56 offen offset:0 sc1
v_cvt_pk_bf16_f32 v24, v120, v121
v_cvt_pk_bf16_f32 v25, v122, v123
v_cvt_pk_bf16_f32 v26, v124, v125
v_cvt_pk_bf16_f32 v27, v126, v127
buffer_store_dwordx4 v[24:27], v5, s[16:19], s56 offen offset:1024 sc1
s_add_u32 m0, s47, 65536
v_dot2_f32_bf16 v128, v20, v28, 0
buffer_load_dwordx4 v32, s[28:31], s67 offen lds
v_dot2_f32_bf16 v129, v20, v20, 0
v_dot2_f32_bf16 v130, v21, v28, 0
v_dot2_f32_bf16 v131, v21, v21, 0
v_dot2_f32_bf16 v128, v22, v28, v128
v_dot2_f32_bf16 v129, v22, v22, v129
v_dot2_f32_bf16 v130, v23, v28, v130
v_dot2_f32_bf16 v131, v23, v23, v131
v_dot2_f32_bf16 v128, v24, v28, v128
v_dot2_f32_bf16 v129, v24, v24, v129
s_add_u32 m0, s47, 69632
v_dot2_f32_bf16 v130, v25, v28, v130
buffer_load_dwordx4 v33, s[28:31], s67 offen lds
v_dot2_f32_bf16 v131, v25, v25, v131
v_dot2_f32_bf16 v128, v26, v28, v128
v_dot2_f32_bf16 v129, v26, v26, v129
v_dot2_f32_bf16 v130, v27, v28, v130
v_dot2_f32_bf16 v131, v27, v27, v131
s_nop 2
v_pk_add_f32 v[128:129], v[128:129], v[130:131]
v_mov_b32 v1, v128
v_mov_b32 v2, v129
s_nop 0
v_permlane16_swap_b32 v128, v1
s_add_u32 m0, s47, 73728
v_permlane16_swap_b32 v129, v2
buffer_load_dwordx4 v34, s[28:31], s67 offen lds
v_add_f32 v128, v128, v1
v_add_f32 v129, v129, v2
v_mov_b32 v1, v128
v_mov_b32 v2, v129
s_nop 0
v_permlane32_swap_b32 v128, v1
v_permlane32_swap_b32 v129, v2
v_add_f32 v128, v128, v1
v_add_f32 v129, v129, v2
v_or_b32 v129, 0x80000000, v129
s_add_u32 m0, s47, 77824
ds_read_b64_tr_b16 v[196:197], v50 offset:0
buffer_load_dwordx4 v35, s[28:31], s67 offen lds
ds_read_b64_tr_b16 v[198:199], v50 offset:3584
ds_read_b64_tr_b16 v[200:201], v51 offset:0
ds_read_b64_tr_b16 v[202:203], v51 offset:3584
ds_read_b64_tr_b16 v[204:205], v50 offset:7168
ds_read_b64_tr_b16 v[206:207], v50 offset:10752
ds_read_b64_tr_b16 v[208:209], v51 offset:7168
ds_read_b64_tr_b16 v[210:211], v51 offset:10752
ds_read_b64_tr_b16 v[212:213], v50 offset:14336
ds_read_b64_tr_b16 v[214:215], v50 offset:17920
s_add_u32 m0, s47, 81920
ds_read_b64_tr_b16 v[216:217], v51 offset:14336
buffer_load_dwordx4 v36, s[28:31], s67 offen lds
ds_read_b64_tr_b16 v[218:219], v51 offset:17920
s_waitcnt lgkmcnt(8)
v_mfma_f32_16x16x32_bf16 v[140:143], v[196:199], v[28:31], 0
ds_read_b64_tr_b16 v[220:221], v50 offset:21504
ds_read_b64_tr_b16 v[222:223], v50 offset:25088
v_mfma_f32_16x16x32_bf16 v[144:147], v[200:203], v[28:31], 0
ds_read_b64_tr_b16 v[224:225], v51 offset:21504
ds_read_b64_tr_b16 v[226:227], v51 offset:25088
s_waitcnt lgkmcnt(8)
v_mfma_f32_16x16x32_bf16 v[140:143], v[204:207], v[28:31], v[140:143]
ds_read_b64_tr_b16 v[228:229], v46 offset:0
s_add_u32 m0, s47, 86016
ds_read_b64_tr_b16 v[230:231], v46 offset:3584
buffer_load_dwordx4 v37, s[28:31], s67 offen lds
v_mfma_f32_16x16x32_bf16 v[144:147], v[208:211], v[28:31], v[144:147]
ds_read_b64_tr_b16 v[232:233], v47 offset:0
ds_read_b64_tr_b16 v[234:235], v47 offset:3584
s_waitcnt lgkmcnt(8)
v_mfma_f32_16x16x32_bf16 v[140:143], v[212:215], v[28:31], v[140:143]
ds_read_b64_tr_b16 v[236:237], v46 offset:7168
ds_read_b64_tr_b16 v[238:239], v46 offset:10752
v_mfma_f32_16x16x32_bf16 v[144:147], v[216:219], v[28:31], v[144:147]
ds_read_b64_tr_b16 v[240:241], v47 offset:7168
ds_read_b64_tr_b16 v[242:243], v47 offset:10752
s_add_u32 m0, s47, 90112
s_waitcnt lgkmcnt(8)
v_mfma_f32_16x16x32_bf16 v[140:143], v[220:223], v[28:31], v[140:143]
buffer_load_dwordx4 v38, s[28:31], s67 offen lds
ds_read_b64_tr_b16 v[196:197], v46 offset:14336
ds_read_b64_tr_b16 v[198:199], v46 offset:17920
v_mfma_f32_16x16x32_bf16 v[144:147], v[224:227], v[28:31], v[144:147]
ds_read_b64_tr_b16 v[200:201], v47 offset:14336
ds_read_b64_tr_b16 v[202:203], v47 offset:17920
s_waitcnt lgkmcnt(8)
v_mfma_f32_16x16x32_bf16 v[140:143], v[228:231], v[28:31], v[140:143]
ds_read_b64_tr_b16 v[204:205], v46 offset:21504
ds_read_b64_tr_b16 v[206:207], v46 offset:25088
v_mfma_f32_16x16x32_bf16 v[144:147], v[232:235], v[28:31], v[144:147]
ds_read_b64_tr_b16 v[208:209], v47 offset:21504
ds_read_b64_tr_b16 v[210:211], v47 offset:25088
s_waitcnt lgkmcnt(8)
v_mfma_f32_16x16x32_bf16 v[140:143], v[236:239], v[28:31], v[140:143]
v_mfma_f32_16x16x32_bf16 v[144:147], v[240:243], v[28:31], v[144:147]
s_waitcnt lgkmcnt(4)
v_mfma_f32_16x16x32_bf16 v[140:143], v[196:199], v[28:31], v[140:143]
v_mfma_f32_16x16x32_bf16 v[144:147], v[200:203], v[28:31], v[144:147]
s_waitcnt lgkmcnt(0)
v_mfma_f32_16x16x32_bf16 v[140:143], v[204:207], v[28:31], v[140:143]
v_mfma_f32_16x16x32_bf16 v[144:147], v[208:211], v[28:31], v[144:147]
s_lshl_b32 s55, s53, 2
s_add_u32 s55, s55, s3
s_lshl_b32 s7, s55, 11
s_add_u32 s7, s7, 0x600000
s_lshl_b32 s59, s55, 3
s_add_u32 s59, s59, s6
s_lshl_b32 s59, s59, 12
s_add_u32 s59, s59, 0x400000
s_xor_b32 s60, s59, 0x1000
s_xor_b32 s61, s59, 0x2000
s_xor_b32 s62, s59, 0x3000
s_waitcnt vmcnt(7)
s_mov_b64 exec, 0xffff
buffer_store_dwordx2 v[128:129], v4, s[16:19], s57 offen sc1
s_mov_b64 exec, -1
s_add_u32 s44, s68, 0
s_add_u32 m0, s48, 0
s_nop 0
buffer_load_dwordx4 v10, s[32:35], s44 offen offset:0 lds
buffer_load_dwordx4 v11, s[32:35], s44 offen offset:1024 lds
buffer_load_dwordx4 v12, s[32:35], s44 offen offset:2048 lds
buffer_load_dwordx4 v13, s[32:35], s44 offen offset:3072 lds
s_add_u32 s44, s69, 0
s_add_u32 m0, s48, 4096
s_nop 0
buffer_load_dwordx4 v10, s[32:35], s44 offen offset:0 lds
buffer_load_dwordx4 v11, s[32:35], s44 offen offset:1024 lds
buffer_load_dwordx4 v12, s[32:35], s44 offen offset:2048 lds
buffer_load_dwordx4 v13, s[32:35], s44 offen offset:3072 lds
s_waitcnt vmcnt(9)
s_barrier
ds_read_b64_tr_b16 v[212:213], v46 offset:32768
ds_read_b64_tr_b16 v[214:215], v46 offset:36352
ds_read_b64_tr_b16 v[216:217], v47 offset:32768
ds_read_b64_tr_b16 v[218:219], v47 offset:36352
ds_read_b64_tr_b16 v[220:221], v46 offset:39936
ds_read_b64_tr_b16 v[222:223], v46 offset:43520
ds_read_b64_tr_b16 v[224:225], v47 offset:39936
ds_read_b64_tr_b16 v[226:227], v47 offset:43520
ds_read_b64_tr_b16 v[228:229], v46 offset:47104
ds_read_b64_tr_b16 v[230:231], v46 offset:50688
ds_read_b64_tr_b16 v[232:233], v47 offset:47104
ds_read_b64_tr_b16 v[234:235], v47 offset:50688
s_waitcnt lgkmcnt(8)
v_mfma_f32_16x16x32_bf16 v[140:143], v[212:215], v[28:31], v[140:143]
ds_read_b64_tr_b16 v[236:237], v46 offset:54272
ds_read_b64_tr_b16 v[238:239], v46 offset:57856
v_mfma_f32_16x16x32_bf16 v[144:147], v[216:219], v[28:31], v[144:147]
ds_read_b64_tr_b16 v[240:241], v47 offset:54272
ds_read_b64_tr_b16 v[242:243], v47 offset:57856
s_waitcnt lgkmcnt(8)
v_mfma_f32_16x16x32_bf16 v[140:143], v[220:223], v[28:31], v[140:143]
ds_read_b64_tr_b16 v[196:197], v48 offset:0
ds_read_b64_tr_b16 v[198:199], v48 offset:3584
v_mfma_f32_16x16x32_bf16 v[144:147], v[224:227], v[28:31], v[144:147]
ds_read_b64_tr_b16 v[200:201], v49 offset:0
ds_read_b64_tr_b16 v[202:203], v49 offset:3584
s_waitcnt lgkmcnt(8)
v_mfma_f32_16x16x32_bf16 v[140:143], v[228:231], v[28:31], v[140:143]
ds_read_b64_tr_b16 v[204:205], v48 offset:7168
ds_read_b64_tr_b16 v[206:207], v48 offset:10752
v_mfma_f32_16x16x32_bf16 v[144:147], v[232:235], v[28:31], v[144:147]
ds_read_b64_tr_b16 v[208:209], v49 offset:7168
ds_read_b64_tr_b16 v[210:211], v49 offset:10752
s_waitcnt lgkmcnt(8)
v_mfma_f32_16x16x32_bf16 v[140:143], v[236:239], v[28:31], v[140:143]
ds_read_b64_tr_b16 v[212:213], v48 offset:14336
ds_read_b64_tr_b16 v[214:215], v48 offset:17920
v_mfma_f32_16x16x32_bf16 v[144:147], v[240:243], v[28:31], v[144:147]
ds_read_b64_tr_b16 v[216:217], v49 offset:14336
ds_read_b64_tr_b16 v[218:219], v49 offset:17920
s_waitcnt lgkmcnt(8)
v_mfma_f32_16x16x32_bf16 v[140:143], v[196:199], v[28:31], v[140:143]
ds_read_b64_tr_b16 v[220:221], v48 offset:21504
ds_read_b64_tr_b16 v[222:223], v48 offset:25088
v_mfma_f32_16x16x32_bf16 v[144:147], v[200:203], v[28:31], v[144:147]
ds_read_b64_tr_b16 v[224:225], v49 offset:21504
ds_read_b64_tr_b16 v[226:227], v49 offset:25088
s_waitcnt lgkmcnt(8)
v_mfma_f32_16x16x32_bf16 v[140:143], v[204:207], v[28:31], v[140:143]
v_mfma_f32_16x16x32_bf16 v[144:147], v[208:211], v[28:31], v[144:147]
s_waitcnt lgkmcnt(4)
v_mfma_f32_16x16x32_bf16 v[140:143], v[212:215], v[28:31], v[140:143]
v_mfma_f32_16x16x32_bf16 v[144:147], v[216:219], v[28:31], v[144:147]
s_waitcnt lgkmcnt(0)
v_mfma_f32_16x16x32_bf16 v[140:143], v[220:223], v[28:31], v[140:143]
v_mfma_f32_16x16x32_bf16 v[144:147], v[224:227], v[28:31], v[144:147]
s_mov_b32 exec_lo, 0x000f000f
s_mov_b32 exec_hi, 0x000f000f
s_nop 4
ds_write_b128 v54, v[140:143]
ds_write_b128 v54, v[144:147] offset:256
s_mov_b64 exec, -1
s_lshl_b32 s63, s55, 4
s_add_u32 s63, s63, s54
s_mul_i32 s56, s63, 7168
s_add_u32 s56, s56, 0x800000
s_add_u32 s57, s56, 3072
s_lshl_b32 s58, s63, 7
s_add_u32 s58, s58, 0x760000
s_waitcnt lgkmcnt(0)
s_barrier
ds_read_b128 v[112:115], v55 offset:0
ds_read_b128 v[116:119], v55 offset:64
ds_read_b128 v[120:123], v55 offset:128
ds_read_b128 v[124:127], v55 offset:192
ds_read_b128 v[128:131], v55 offset:256
ds_read_b128 v[132:135], v55 offset:320
ds_read_b128 v[136:139], v55 offset:384
ds_read_b64_tr_b16 v[196:197], v44 offset:0
ds_read_b64_tr_b16 v[198:199], v44 offset:3584
ds_read_b64_tr_b16 v[200:201], v44 offset:32
ds_read_b64_tr_b16 v[202:203], v44 offset:3616
ds_read_b64_tr_b16 v[204:205], v44 offset:64
ds_read_b64_tr_b16 v[206:207], v44 offset:3648
ds_read_b64_tr_b16 v[208:209], v44 offset:96
ds_read_b64_tr_b16 v[210:211], v44 offset:3680
ds_read_b64_tr_b16 v[212:213], v44 offset:7168
ds_read_b64_tr_b16 v[214:215], v44 offset:10752
ds_read_b64_tr_b16 v[216:217], v44 offset:7200
ds_read_b64_tr_b16 v[218:219], v44 offset:10784
ds_read_b64_tr_b16 v[220:221], v44 offset:7232
ds_read_b64_tr_b16 v[222:223], v44 offset:10816
ds_read_b64_tr_b16 v[224:225], v44 offset:7264
ds_read_b64_tr_b16 v[226:227], v44 offset:10848
s_add_u32 s44, s70, 0
s_mov_b32 m0, s96
s_waitcnt lgkmcnt(15)
buffer_load_dwordx4 v10, s[32:35], s44 offen offset:0 lds
buffer_load_dwordx4 v11, s[32:35], s44 offen offset:1024 lds
buffer_load_dwordx4 v12, s[32:35], s44 offen offset:2048 lds
buffer_load_dwordx4 v13, s[32:35], s44 offen offset:3072 lds
s_waitcnt vmcnt(8)
ds_read_b64_tr_b16 a[128:129], v14 offset:32768
ds_read_b64_tr_b16 a[130:131], v14 offset:34816
ds_read_b64_tr_b16 a[132:133], v15 offset:32768
ds_read_b64_tr_b16 a[134:135], v15 offset:34816
ds_read_b64_tr_b16 a[136:137], v16 offset:32768
ds_read_b64_tr_b16 a[138:139], v16 offset:34816
ds_read_b64_tr_b16 a[140:141], v17 offset:32768
ds_read_b64_tr_b16 a[142:143], v17 offset:34816
s_waitcnt vmcnt(4)
ds_read_b64_tr_b16 a[144:145], v14 offset:36864
ds_read_b64_tr_b16 a[146:147], v14 offset:38912
ds_read_b64_tr_b16 a[148:149], v15 offset:36864
ds_read_b64_tr_b16 a[150:151], v15 offset:38912
ds_read_b64_tr_b16 a[152:153], v16 offset:36864
ds_read_b64_tr_b16 a[154:155], v16 offset:38912
ds_read_b64_tr_b16 a[156:157], v17 offset:36864
ds_read_b64_tr_b16 a[158:159], v17 offset:38912
buffer_load_dwordx2 v[60:61], v52, s[16:19], s7 offen offset:0 sc1
buffer_load_dwordx2 v[62:63], v52, s[16:19], s7 offen offset:128 sc1
buffer_load_dwordx2 v[64:65], v52, s[16:19], s7 offen offset:1024 sc1
buffer_load_dwordx2 v[66:67], v52, s[16:19], s7 offen offset:1152 sc1
s_add_u32 s44, s71, 0
s_add_u32 m0, s48, 0
s_waitcnt lgkmcnt(8)
buffer_load_dwordx4 v10, s[32:35], s44 offen offset:0 lds
buffer_load_dwordx4 v11, s[32:35], s44 offen offset:1024 lds
buffer_load_dwordx4 v12, s[32:35], s44 offen offset:2048 lds
buffer_load_dwordx4 v13, s[32:35], s44 offen offset:3072 lds
s_add_u32 s44, s68, 32768
s_add_u32 m0, s48, 4096
s_waitcnt lgkmcnt(0)
buffer_load_dwordx4 v10, s[32:35], s44 offen offset:0 lds
buffer_load_dwordx4 v11, s[32:35], s44 offen offset:1024 lds
buffer_load_dwordx4 v12, s[32:35], s44 offen offset:2048 lds
buffer_load_dwordx4 v13, s[32:35], s44 offen offset:3072 lds
s_mov_b32 s63, 1000000
s_waitcnt vmcnt(8)
s_branch L_chkC
L_pollC:
buffer_load_dwordx2 v[60:61], v52, s[16:19], s7 offen offset:0 sc1
buffer_load_dwordx2 v[62:63], v52, s[16:19], s7 offen offset:128 sc1
buffer_load_dwordx2 v[64:65], v52, s[16:19], s7 offen offset:1024 sc1
buffer_load_dwordx2 v[66:67], v52, s[16:19], s7 offen offset:1152 sc1
s_waitcnt vmcnt(0)
L_chkC:
v_min3_u32 v1, v61, v63, v65
v_min_u32 v1, v1, v67
v_cmp_eq_u32 vcc, 0, v1
s_cbranch_vccz L_okC
s_sub_u32 s63, s63, 1
s_cbranch_scc0 L_pollC
L_okC:
buffer_load_dwordx4 a[0:3], v5, s[16:19], s59 offen offset:0 sc1
buffer_load_dwordx4 a[4:7], v53, s[16:19], s59 offen offset:0 sc1
buffer_load_dwordx4 a[8:11], v5, s[16:19], s59 offen offset:1024 sc1
v_pk_add_f32 v[60:61], v[60:61], v[62:63]
v_pk_add_f32 v[64:65], v[64:65], v[66:67]
v_mov_b32 v76, v60
v_mov_b32 v77, v61
v_mov_b32 v78, v64
v_mov_b32 v79, v65
v_permlane16_swap_b32 v60, v76
v_permlane16_swap_b32 v61, v77
v_permlane16_swap_b32 v64, v78
v_permlane16_swap_b32 v65, v79
v_add_f32 v60, v60, v76
v_add_f32 v61, v61, v77
buffer_load_dwordx4 a[12:15], v53, s[16:19], s59 offen offset:1024 sc1
v_add_f32 v64, v64, v78
v_add_f32 v65, v65, v79
v_mov_b32 v76, v60
v_mov_b32 v77, v61
v_mov_b32 v78, v64
v_mov_b32 v79, v65
v_permlane32_swap_b32 v60, v76
v_permlane32_swap_b32 v61, v77
v_permlane32_swap_b32 v64, v78
v_permlane32_swap_b32 v65, v79
v_add_f32 v60, v60, v76
v_add_f32 v61, v61, v77
buffer_load_dwordx4 a[16:19], v5, s[16:19], s59 offen offset:2048 sc1
v_add_f32 v64, v64, v78
v_add_f32 v65, v65, v79
v_mul_f32 v60, 0xbb000000, v60
v_mul_f32 v64, 0xbb000000, v64
v_mul_f32 v61, 0xbb000000, v61
v_mul_f32 v65, 0xbb000000, v65
v_fma_f32 v61, -v60, v60, v61
v_fma_f32 v65, -v64, v64, v65
v_max_f32 v61, 0, v61
v_max_f32 v65, 0, v65
v_add_f32 v61, 0x3727c5ac, v61
v_add_f32 v65, 0x3727c5ac, v65
buffer_load_dwordx4 a[20:23], v53, s[16:19], s59 offen offset:2048 sc1
v_rsq_f32 v62, v61
v_rsq_f32 v66, v65
v_mul_f32 v61, v61, v62
v_mul_f32 v65, v65, v66
v_mul_f32 v62, 0x3fb8aa3b, v62
v_mul_f32 v66, 0x3fb8aa3b, v66
v_pk_mul_f32 v[140:141], v[84:85], v[60:61] op_sel:[0,1] op_sel_hi:[1,1]
v_pk_mul_f32 v[142:143], v[86:87], v[60:61] op_sel:[0,1] op_sel_hi:[1,1]
v_pk_mul_f32 v[144:145], v[84:85], v[64:65] op_sel:[0,1] op_sel_hi:[1,1]
v_pk_mul_f32 v[146:147], v[86:87], v[64:65] op_sel:[0,1] op_sel_hi:[1,1]
s_waitcnt lgkmcnt(15)
v_pk_fma_f32 v[140:141], v[112:113], v[60:61], v[140:141] op_sel_hi:[1,0,1]
v_pk_fma_f32 v[142:143], v[114:115], v[60:61], v[142:143] op_sel_hi:[1,0,1]
buffer_load_dwordx4 a[24:27], v5, s[16:19], s59 offen offset:3072 sc1
v_pk_fma_f32 v[144:145], v[112:113], v[64:65], v[144:145] op_sel_hi:[1,0,1]
v_pk_fma_f32 v[146:147], v[114:115], v[64:65], v[146:147] op_sel_hi:[1,0,1]
v_pk_mul_f32 v[148:149], v[88:89], v[60:61] op_sel:[0,1] op_sel_hi:[1,1]
v_pk_mul_f32 v[150:151], v[90:91], v[60:61] op_sel:[0,1] op_sel_hi:[1,1]
v_pk_mul_f32 v[152:153], v[88:89], v[64:65] op_sel:[0,1] op_sel_hi:[1,1]
v_pk_mul_f32 v[154:155], v[90:91], v[64:65] op_sel:[0,1] op_sel_hi:[1,1]
v_pk_fma_f32 v[148:149], v[116:117], v[60:61], v[148:149] op_sel_hi:[1,0,1]
v_pk_fma_f32 v[150:151], v[118:119], v[60:61], v[150:151] op_sel_hi:[1,0,1]
v_pk_fma_f32 v[152:153], v[116:117], v[64:65], v[152:153] op_sel_hi:[1,0,1]
v_pk_fma_f32 v[154:155], v[118:119], v[64:65], v[154:155] op_sel_hi:[1,0,1]
v_pk_mul_f32 v[156:157], v[92:93], v[60:61] op_sel:[0,1] op_sel_hi:[1,1]
v_pk_mul_f32 v[158:159], v[94:95], v[60:61] op_sel:[0,1] op_sel_hi:[1,1]
buffer_load_dwordx4 a[28:31], v53, s[16:19], s59 offen offset:3072 sc1
v_pk_mul_f32 v[160:161], v[92:93], v[64:65] op_sel:[0,1] op_sel_hi:[1,1]
v_pk_mul_f32 v[162:163], v[94:95], v[64:65] op_sel:[0,1] op_sel_hi:[1,1]
v_pk_fma_f32 v[156:157], v[120:121], v[60:61], v[156:157] op_sel_hi:[1,0,1]
v_pk_fma_f32 v[158:159], v[122:123], v[60:61], v[158:159] op_sel_hi:[1,0,1]
v_pk_fma_f32 v[160:161], v[120:121], v[64:65], v[160:161] op_sel_hi:[1,0,1]
v_pk_fma_f32 v[162:163], v[122:123], v[64:65], v[162:163] op_sel_hi:[1,0,1]
v_pk_mul_f32 v[164:165], v[96:97], v[60:61] op_sel:[0,1] op_sel_hi:[1,1]
v_pk_mul_f32 v[166:167], v[98:99], v[60:61] op_sel:[0,1] op_sel_hi:[1,1]
v_pk_mul_f32 v[168:169], v[96:97], v[64:65] op_sel:[0,1] op_sel_hi:[1,1]
v_pk_mul_f32 v[170:171], v[98:99], v[64:65] op_sel:[0,1] op_sel_hi:[1,1]
v_pk_fma_f32 v[164:165], v[124:125], v[60:61], v[164:165] op_sel_hi:[1,0,1]
v_pk_fma_f32 v[166:167], v[126:127], v[60:61], v[166:167] op_sel_hi:[1,0,1]
buffer_load_dwordx4 a[32:35], v5, s[16:19], s60 offen offset:0 sc1
v_pk_fma_f32 v[168:169], v[124:125], v[64:65], v[168:169] op_sel_hi:[1,0,1]
v_pk_fma_f32 v[170:171], v[126:127], v[64:65], v[170:171] op_sel_hi:[1,0,1]
v_pk_mul_f32 v[172:173], v[100:101], v[60:61] op_sel:[0,1] op_sel_hi:[1,1]
v_pk_mul_f32 v[174:175], v[102:103], v[60:61] op_sel:[0,1] op_sel_hi:[1,1]
v_pk_mul_f32 v[176:177], v[100:101], v[64:65] op_sel:[0,1] op_sel_hi:[1,1]
v_pk_mul_f32 v[178:179], v[102:103], v[64:65] op_sel:[0,1] op_sel_hi:[1,1]
v_pk_fma_f32 v[172:173], v[128:129], v[60:61], v[172:173] op_sel_hi:[1,0,1]
v_pk_fma_f32 v[174:175], v[130:131], v[60:61], v[174:175] op_sel_hi:[1,0,1]
v_pk_fma_f32 v[176:177], v[128:129], v[64:65], v[176:177] op_sel_hi:[1,0,1]
v_pk_fma_f32 v[178:179], v[130:131], v[64:65], v[178:179] op_sel_hi:[1,0,1]
v_pk_mul_f32 v[180:181], v[104:105], v[60:61] op_sel:[0,1] op_sel_hi:[1,1]
v_pk_mul_f32 v[182:183], v[106:107], v[60:61] op_sel:[0,1] op_sel_hi:[1,1]
buffer_load_dwordx4 a[36:39], v53, s[16:19], s60 offen offset:0 sc1
v_pk_mul_f32 v[184:185], v[104:105], v[64:65] op_sel:[0,1] op_sel_hi:[1,1]
v_pk_mul_f32 v[186:187], v[106:107], v[64:65] op_sel:[0,1] op_sel_hi:[1,1]
v_pk_fma_f32 v[180:181], v[132:133], v[60:61], v[180:181] op_sel_hi:[1,0,1]
v_pk_fma_f32 v[182:183], v[134:135], v[60:61], v[182:183] op_sel_hi:[1,0,1]
v_pk_fma_f32 v[184:185], v[132:133], v[64:65], v[184:185] op_sel_hi:[1,0,1]
v_pk_fma_f32 v[186:187], v[134:135], v[64:65], v[186:187] op_sel_hi:[1,0,1]
v_pk_mul_f32 v[188:189], v[108:109], v[60:61] op_sel:[0,1] op_sel_hi:[1,1]
v_pk_mul_f32 v[190:191], v[110:111], v[60:61] op_sel:[0,1] op_sel_hi:[1,1]
v_pk_mul_f32 v[192:193], v[108:109], v[64:65] op_sel:[0,1] op_sel_hi:[1,1]
v_pk_mul_f32 v[194:195], v[110:111], v[64:65] op_sel:[0,1] op_sel_hi:[1,1]
v_pk_fma_f32 v[188:189], v[136:137], v[60:61], v[188:189] op_sel_hi:[1,0,1]
v_pk_fma_f32 v[190:191], v[138:139], v[60:61], v[190:191] op_sel_hi:[1,0,1]
v_pk_fma_f32 v[192:193], v[136:137], v[64:65], v[192:193] op_sel_hi:[1,0,1]
v_pk_fma_f32 v[194:195], v[138:139], v[64:65], v[194:195] op_sel_hi:[1,0,1]
s_waitcnt vmcnt(8)
s_waitcnt lgkmcnt(15)
v_mfma_f32_16x16x32_bf16 v[140:143], v[196:199], a[0:3], v[140:143]
ds_read_b64_tr_b16 v[228:229], v44 offset:14336
ds_read_b64_tr_b16 a[160:161], v56 offset:0
v_add_u32 v46, s48, v5
v_mfma_f32_16x16x32_bf16 v[144:147], v[196:199], a[4:7], v[144:147]
ds_read_b64_tr_b16 v[230:231], v44 offset:17920
buffer_load_dwordx4 a[40:43], v5, s[16:19], s60 offen offset:1024 sc1
v_mfma_f32_16x16x32_bf16 v[148:151], v[200:203], a[0:3], v[148:151]
ds_read_b64_tr_b16 v[232:233], v44 offset:14368
ds_read_b64_tr_b16 a[162:163], v56 offset:2048
v_add_u32 v47, s96, v5
v_mfma_f32_16x16x32_bf16 v[152:155], v[200:203], a[4:7], v[152:155]
ds_read_b64_tr_b16 v[234:235], v44 offset:17952
ds_read_b64_tr_b16 a[164:165], v57 offset:0
v_xor_b32 v48, 0x2000, v46
v_mfma_f32_16x16x32_bf16 v[156:159], v[204:207], a[0:3], v[156:159]
ds_read_b64_tr_b16 v[236:237], v44 offset:14400
ds_read_b64_tr_b16 a[166:167], v57 offset:2048
v_xor_b32 v49, 0x4000, v46
v_mfma_f32_16x16x32_bf16 v[160:163], v[204:207], a[4:7], v[160:163]
ds_read_b64_tr_b16 v[238:239], v44 offset:17984
buffer_load_dwordx4 a[44:47], v53, s[16:19], s60 offen offset:1024 sc1
v_mfma_f32_16x16x32_bf16 v[164:167], v[208:211], a[0:3], v[164:167]
ds_read_b64_tr_b16 v[240:241], v44 offset:14432
ds_read_b64_tr_b16 a[168:169], v58 offset:0
s_xor_b32 s63, s3, 3
v_mfma_f32_16x16x32_bf16 v[168:171], v[208:211], a[4:7], v[168:171]
ds_read_b64_tr_b16 v[242:243], v44 offset:18016
ds_read_b64_tr_b16 a[170:171], v58 offset:2048
s_lshl_b32 s63, s63, 15
s_waitcnt vmcnt(8)
s_waitcnt lgkmcnt(15)
v_mfma_f32_16x16x32_bf16 v[140:143], v[212:215], a[8:11], v[140:143]
ds_read_b64_tr_b16 v[196:197], v44 offset:21504
ds_read_b64_tr_b16 a[172:173], v59 offset:0
s_cmp_eq_u32 s3, 0
s_cselect_b32 s63, 0x20000, s63
v_mfma_f32_16x16x32_bf16 v[144:147], v[212:215], a[12:15], v[144:147]
ds_read_b64_tr_b16 v[198:199], v44 offset:25088
buffer_load_dwordx4 a[48:51], v5, s[16:19], s60 offen offset:2048 sc1
v_mfma_f32_16x16x32_bf16 v[148:151], v[216:219], a[8:11], v[148:151]
ds_read_b64_tr_b16 v[200:201], v44 offset:21536
ds_read_b64_tr_b16 a[174:175], v59 offset:2048
s_add_u32 s63, s63, 28672
v_mfma_f32_16x16x32_bf16 v[152:155], v[216:219], a[12:15], v[152:155]
ds_read_b64_tr_b16 v[202:203], v44 offset:25120
ds_read_b64_tr_b16 a[176:177], v14 offset:32768
v_add_u32 v50, s63, v5
v_mfma_f32_16x16x32_bf16 v[156:159], v[220:223], a[8:11], v[156:159]
ds_read_b64_tr_b16 v[204:205], v44 offset:21568
ds_read_b64_tr_b16 a[178:179], v14 offset:34816
s_xor_b32 s63, s1, 0
v_mfma_f32_16x16x32_bf16 v[160:163], v[220:223], a[12:15], v[160:163]
ds_read_b64_tr_b16 v[206:207], v44 offset:25152
buffer_load_dwordx4 a[52:55], v53, s[16:19], s60 offen offset:2048 sc1
v_mfma_f32_16x16x32_bf16 v[164:167], v[224:227], a[8:11], v[164:167]
ds_read_b64_tr_b16 v[208:209], v44 offset:21600
ds_read_b64_tr_b16 a[180:181], v15 offset:32768
s_lshr_b32 s97, s63, 1
v_mfma_f32_16x16x32_bf16 v[168:171], v[224:227], a[12:15], v[168:171]
ds_read_b64_tr_b16 v[210:211], v44 offset:25184
ds_read_b64_tr_b16 a[182:183], v15 offset:34816
s_mul_i32 s97, s97, 114688
s_waitcnt vmcnt(8)
s_waitcnt lgkmcnt(15)
v_mfma_f32_16x16x32_bf16 v[140:143], v[228:231], a[16:19], v[140:143]
ds_read_b64_tr_b16 v[212:213], v42 offset:0
ds_read_b64_tr_b16 a[184:185], v16 offset:32768
v_add_u32 v36, s97, v5
v_mfma_f32_16x16x32_bf16 v[144:147], v[228:231], a[20:23], v[144:147]
ds_read_b64_tr_b16 v[214:215], v42 offset:3584
buffer_load_dwordx4 a[56:59], v5, s[16:19], s60 offen offset:3072 sc1
v_mfma_f32_16x16x32_bf16 v[148:151], v[232:235], a[16:19], v[148:151]
ds_read_b64_tr_b16 v[216:217], v42 offset:32
ds_read_b64_tr_b16 a[186:187], v16 offset:34816
v_add_u32 v36, 6144, v36
v_mfma_f32_16x16x32_bf16 v[152:155], v[232:235], a[20:23], v[152:155]
ds_read_b64_tr_b16 v[218:219], v42 offset:3616
ds_read_b64_tr_b16 a[188:189], v17 offset:32768
s_and_b32 s63, s63, 1
v_mfma_f32_16x16x32_bf16 v[156:159], v[236:239], a[16:19], v[156:159]
ds_read_b64_tr_b16 v[220:221], v42 offset:64
ds_read_b64_tr_b16 a[190:191], v17 offset:34816
s_mul_i32 s63, s63, 3072
v_mfma_f32_16x16x32_bf16 v[160:163], v[236:239], a[20:23], v[160:163]
ds_read_b64_tr_b16 v[222:223], v42 offset:3648
buffer_load_dwordx4 a[60:63], v53, s[16:19], s60 offen offset:3072 sc1
v_mfma_f32_16x16x32_bf16 v[164:167], v[240:243], a[16:19], v[164:167]
ds_read_b64_tr_b16 v[224:225], v42 offset:96
ds_read_b64_tr_b16 a[192:193], v14 offset:36864
s_add_u32 s97, s97, s63
v_mfma_f32_16x16x32_bf16 v[168:171], v[240:243], a[20:23], v[168:171]
ds_read_b64_tr_b16 v[226:227], v42 offset:3680
ds_read_b64_tr_b16 a[194:195], v14 offset:38912
v_add_u32 v32, s97, v5
s_waitcnt vmcnt(8)
s_waitcnt lgkmcnt(15)
v_mfma_f32_16x16x32_bf16 v[140:143], v[196:199], a[24:27], v[140:143]
ds_read_b64_tr_b16 v[228:229], v42 offset:7168
ds_read_b64_tr_b16 a[196:197], v15 offset:36864
s_xor_b32 s63, s1, 1
v_mfma_f32_16x16x32_bf16 v[144:147], v[196:199], a[28:31], v[144:147]
ds_read_b64_tr_b16 v[230:231], v42 offset:10752
buffer_load_dwordx4 a[64:67], v5, s[16:19], s61 offen offset:0 sc1
v_mfma_f32_16x16x32_bf16 v[148:151], v[200:203], a[24:27], v[148:151]
ds_read_b64_tr_b16 v[232:233], v42 offset:7200
ds_read_b64_tr_b16 a[198:199], v15 offset:38912
s_lshr_b32 s97, s63, 1
v_mfma_f32_16x16x32_bf16 v[152:155], v[200:203], a[28:31], v[152:155]
ds_read_b64_tr_b16 v[234:235], v42 offset:10784
ds_read_b64_tr_b16 a[200:201], v16 offset:36864
s_mul_i32 s97, s97, 114688
v_mfma_f32_16x16x32_bf16 v[156:159], v[204:207], a[24:27], v[156:159]
ds_read_b64_tr_b16 v[236:237], v42 offset:7232
ds_read_b64_tr_b16 a[202:203], v16 offset:38912
s_and_b32 s63, s63, 1
v_mfma_f32_16x16x32_bf16 v[160:163], v[204:207], a[28:31], v[160:163]
ds_read_b64_tr_b16 v[238:239], v42 offset:10816
buffer_load_dwordx4 a[68:71], v53, s[16:19], s61 offen offset:0 sc1
v_mfma_f32_16x16x32_bf16 v[164:167], v[208:211], a[24:27], v[164:167]
ds_read_b64_tr_b16 v[240:241], v42 offset:7264
ds_read_b64_tr_b16 a[204:205], v17 offset:36864
s_mul_i32 s63, s63, 3072
v_mfma_f32_16x16x32_bf16 v[168:171], v[208:211], a[28:31], v[168:171]
ds_read_b64_tr_b16 v[242:243], v42 offset:10848
ds_read_b64_tr_b16 a[206:207], v17 offset:38912
s_add_u32 s97, s97, s63
s_waitcnt vmcnt(8)
s_waitcnt lgkmcnt(15)
v_mfma_f32_16x16x32_bf16 v[140:143], v[212:215], a[32:35], v[140:143]
ds_read_b64_tr_b16 v[196:197], v42 offset:14336
v_add_u32 v33, s97, v5
s_xor_b32 s63, s1, 2
v_mfma_f32_16x16x32_bf16 v[144:147], v[212:215], a[36:39], v[144:147]
ds_read_b64_tr_b16 v[198:199], v42 offset:17920
buffer_load_dwordx4 a[72:75], v5, s[16:19], s61 offen offset:1024 sc1
v_mfma_f32_16x16x32_bf16 v[148:151], v[216:219], a[32:35], v[148:151]
ds_read_b64_tr_b16 v[200:201], v42 offset:14368
s_lshr_b32 s97, s63, 1
s_mul_i32 s97, s97, 114688
v_mfma_f32_16x16x32_bf16 v[152:155], v[216:219], a[36:39], v[152:155]
ds_read_b64_tr_b16 v[202:203], v42 offset:17952
v_add_u32 v37, s97, v5
v_add_u32 v37, 6144, v37
v_mfma_f32_16x16x32_bf16 v[156:159], v[220:223], a[32:35], v[156:159]
ds_read_b64_tr_b16 v[204:205], v42 offset:14400
s_and_b32 s63, s63, 1
s_mul_i32 s63, s63, 3072
v_mfma_f32_16x16x32_bf16 v[160:163], v[220:223], a[36:39], v[160:163]
ds_read_b64_tr_b16 v[206:207], v42 offset:17984
buffer_load_dwordx4 a[76:79], v53, s[16:19], s61 offen offset:1024 sc1
v_mfma_f32_16x16x32_bf16 v[164:167], v[224:227], a[32:35], v[164:167]
ds_read_b64_tr_b16 v[208:209], v42 offset:14432
s_add_u32 s97, s97, s63
v_add_u32 v34, s97, v5
v_mfma_f32_16x16x32_bf16 v[168:171], v[224:227], a[36:39], v[168:171]
ds_read_b64_tr_b16 v[210:211], v42 offset:18016
s_xor_b32 s63, s1, 3
s_lshr_b32 s97, s63, 1
s_waitcnt vmcnt(8)
s_waitcnt lgkmcnt(9)
v_mfma_f32_16x16x32_bf16 v[140:143], v[228:231], a[40:43], v[140:143]
ds_read_b64_tr_b16 v[212:213], v42 offset:21504
s_mul_i32 s97, s97, 114688
s_and_b32 s63, s63, 1
v_mfma_f32_16x16x32_bf16 v[144:147], v[228:231], a[44:47], v[144:147]
ds_read_b64_tr_b16 v[214:215], v42 offset:25088
buffer_load_dwordx4 a[80:83], v5, s[16:19], s61 offen offset:2048 sc1
v_mfma_f32_16x16x32_bf16 v[148:151], v[232:235], a[40:43], v[148:151]
ds_read_b64_tr_b16 v[216:217], v42 offset:21536
s_mul_i32 s63, s63, 3072
s_add_u32 s97, s97, s63
v_mfma_f32_16x16x32_bf16 v[152:155], v[232:235], a[44:47], v[152:155]
ds_read_b64_tr_b16 v[218:219], v42 offset:25120
v_add_u32 v35, s97, v5
s_lshl_b32 s97, s51, 3
v_mfma_f32_16x16x32_bf16 v[156:159], v[236:239], a[40:43], v[156:159]
ds_read_b64_tr_b16 v[220:221], v42 offset:21568
s_add_u32 s97, s97, s3
s_lshl_b32 s97, s97, 2
v_mfma_f32_16x16x32_bf16 v[160:163], v[236:239], a[44:47], v[160:163]
ds_read_b64_tr_b16 v[222:223], v42 offset:25152
buffer_load_dwordx4 a[84:87], v53, s[16:19], s61 offen offset:2048 sc1
v_mfma_f32_16x16x32_bf16 v[164:167], v[240:243], a[40:43], v[164:167]
ds_read_b64_tr_b16 v[224:225], v42 offset:21600
s_xor_b32 s63, s6, 0
s_add_u32 s63, s63, s97
v_mfma_f32_16x16x32_bf16 v[168:171], v[240:243], a[44:47], v[168:171]
ds_read_b64_tr_b16 v[226:227], v42 offset:25184
s_mul_i32 s63, s63, 7168
s_add_u32 s64, s63, 0x800000
s_waitcnt vmcnt(8)
s_waitcnt lgkmcnt(8)
v_mfma_f32_16x16x32_bf16 v[140:143], v[196:199], a[48:51], v[140:143]
ds_read_b64_tr_b16 v[228:229], v42 offset:32768
s_xor_b32 s63, s6, 1
s_add_u32 s63, s63, s97
v_mfma_f32_16x16x32_bf16 v[144:147], v[196:199], a[52:55], v[144:147]
ds_read_b64_tr_b16 v[230:231], v42 offset:36352
buffer_load_dwordx4 a[88:91], v5, s[16:19], s61 offen offset:3072 sc1
v_mfma_f32_16x16x32_bf16 v[148:151], v[200:203], a[48:51], v[148:151]
ds_read_b64_tr_b16 v[232:233], v42 offset:32800
s_mul_i32 s63, s63, 7168
s_add_u32 s65, s63, 0x800000
v_mfma_f32_16x16x32_bf16 v[152:155], v[200:203], a[52:55], v[152:155]
ds_read_b64_tr_b16 v[234:235], v42 offset:36384
s_xor_b32 s63, s6, 2
s_add_u32 s63, s63, s97
v_mfma_f32_16x16x32_bf16 v[156:159], v[204:207], a[48:51], v[156:159]
ds_read_b64_tr_b16 v[236:237], v42 offset:32832
s_mul_i32 s63, s63, 7168
s_add_u32 s66, s63, 0x800000
v_mfma_f32_16x16x32_bf16 v[160:163], v[204:207], a[52:55], v[160:163]
ds_read_b64_tr_b16 v[238:239], v42 offset:36416
buffer_load_dwordx4 a[92:95], v53, s[16:19], s61 offen offset:3072 sc1
v_mfma_f32_16x16x32_bf16 v[164:167], v[208:211], a[48:51], v[164:167]
ds_read_b64_tr_b16 v[240:241], v42 offset:32864
s_xor_b32 s63, s6, 3
s_add_u32 s63, s63, s97
v_mfma_f32_16x16x32_bf16 v[168:171], v[208:211], a[52:55], v[168:171]
ds_read_b64_tr_b16 v[242:243], v42 offset:36448
s_mul_i32 s63, s63, 7168
s_add_u32 s67, s63, 0x800000
s_waitcnt vmcnt(8)
s_waitcnt lgkmcnt(8)
v_mfma_f32_16x16x32_bf16 v[140:143], v[212:215], a[56:59], v[140:143]
ds_read_b64_tr_b16 v[196:197], v42 offset:39936
s_lshl_b32 s97, s97, 7
s_add_u32 s97, s97, 0x760000
v_mfma_f32_16x16x32_bf16 v[144:147], v[212:215], a[60:63], v[144:147]
ds_read_b64_tr_b16 v[198:199], v42 offset:43520
buffer_load_dwordx4 a[96:99], v5, s[16:19], s62 offen offset:0 sc1
v_mfma_f32_16x16x32_bf16 v[148:151], v[216:219], a[56:59], v[148:151]
ds_read_b64_tr_b16 v[200:201], v42 offset:39968
v_bfe_u32 v1, v0, 2, 1
v_lshlrev_b32 v1, 11, v1
v_mfma_f32_16x16x32_bf16 v[152:155], v[216:219], a[60:63], v[152:155]
ds_read_b64_tr_b16 v[202:203], v42 offset:43552
v_and_b32 v2, 3, v0
v_lshl_add_u32 v1, v2, 7, v1
v_mfma_f32_16x16x32_bf16 v[156:159], v[220:223], a[56:59], v[156:159]
ds_read_b64_tr_b16 v[204:205], v42 offset:40000
v_bfe_u32 v2, v0, 3, 2
v_lshl_add_u32 v51, v2, 17, v1
v_mfma_f32_16x16x32_bf16 v[160:163], v[220:223], a[60:63], v[160:163]
ds_read_b64_tr_b16 v[206:207], v42 offset:43584
buffer_load_dwordx4 a[100:103], v53, s[16:19], s62 offen offset:0 sc1
v_mfma_f32_16x16x32_bf16 v[164:167], v[224:227], a[56:59], v[164:167]
ds_read_b64_tr_b16 v[208:209], v42 offset:40032
v_mfma_f32_16x16x32_bf16 v[168:171], v[224:227], a[60:63], v[168:171]
ds_read_b64_tr_b16 v[210:211], v42 offset:43616
s_waitcnt vmcnt(8)
s_waitcnt lgkmcnt(8)
v_mfma_f32_16x16x32_bf16 v[140:143], v[228:231], a[64:67], v[140:143]
ds_read_b64_tr_b16 v[212:213], v42 offset:47104
v_mfma_f32_16x16x32_bf16 v[144:147], v[228:231], a[68:71], v[144:147]
ds_read_b64_tr_b16 v[214:215], v42 offset:50688
buffer_load_dwordx4 a[104:107], v5, s[16:19], s62 offen offset:1024 sc1
v_mfma_f32_16x16x32_bf16 v[148:151], v[232:235], a[64:67], v[148:151]
ds_read_b64_tr_b16 v[216:217], v42 offset:47136
v_mfma_f32_16x16x32_bf16 v[152:155], v[232:235], a[68:71], v[152:155]
ds_read_b64_tr_b16 v[218:219], v42 offset:50720
v_mfma_f32_16x16x32_bf16 v[156:159], v[236:239], a[64:67], v[156:159]
ds_read_b64_tr_b16 v[220:221], v42 offset:47168
v_mfma_f32_16x16x32_bf16 v[160:163], v[236:239], a[68:71], v[160:163]
ds_read_b64_tr_b16 v[222:223], v42 offset:50752
buffer_load_dwordx4 a[108:111], v53, s[16:19], s62 offen offset:1024 sc1
v_mfma_f32_16x16x32_bf16 v[164:167], v[240:243], a[64:67], v[164:167]
ds_read_b64_tr_b16 v[224:225], v42 offset:47200
v_mfma_f32_16x16x32_bf16 v[168:171], v[240:243], a[68:71], v[168:171]
ds_read_b64_tr_b16 v[226:227], v42 offset:50784
s_waitcnt vmcnt(8)
s_waitcnt lgkmcnt(8)
v_mfma_f32_16x16x32_bf16 v[140:143], v[196:199], a[72:75], v[140:143]
ds_read_b64_tr_b16 v[228:229], v42 offset:54272
v_mfma_f32_16x16x32_bf16 v[144:147], v[196:199], a[76:79], v[144:147]
ds_read_b64_tr_b16 v[230:231], v42 offset:57856
buffer_load_dwordx4 a[112:115], v5, s[16:19], s62 offen offset:2048 sc1
v_mfma_f32_16x16x32_bf16 v[148:151], v[200:203], a[72:75], v[148:151]
ds_read_b64_tr_b16 v[232:233], v42 offset:54304
v_mfma_f32_16x16x32_bf16 v[152:155], v[200:203], a[76:79], v[152:155]
ds_read_b64_tr_b16 v[234:235], v42 offset:57888
v_mfma_f32_16x16x32_bf16 v[156:159], v[204:207], a[72:75], v[156:159]
ds_read_b64_tr_b16 v[236:237], v42 offset:54336
v_mfma_f32_16x16x32_bf16 v[160:163], v[204:207], a[76:79], v[160:163]
ds_read_b64_tr_b16 v[238:239], v42 offset:57920
buffer_load_dwordx4 a[116:119], v53, s[16:19], s62 offen offset:2048 sc1
v_mfma_f32_16x16x32_bf16 v[164:167], v[208:211], a[72:75], v[164:167]
ds_read_b64_tr_b16 v[240:241], v42 offset:54368
v_mfma_f32_16x16x32_bf16 v[168:171], v[208:211], a[76:79], v[168:171]
ds_read_b64_tr_b16 v[242:243], v42 offset:57952
s_waitcnt vmcnt(8)
s_waitcnt lgkmcnt(8)
v_mfma_f32_16x16x32_bf16 v[140:143], v[212:215], a[80:83], v[140:143]
ds_read_b64_tr_b16 v[196:197], v43 offset:0
v_mfma_f32_16x16x32_bf16 v[144:147], v[212:215], a[84:87], v[144:147]
ds_read_b64_tr_b16 v[198:199], v43 offset:3584
buffer_load_dwordx4 a[120:123], v5, s[16:19], s62 offen offset:3072 sc1
v_mfma_f32_16x16x32_bf16 v[148:151], v[216:219], a[80:83], v[148:151]
ds_read_b64_tr_b16 v[200:201], v43 offset:32
v_mfma_f32_16x16x32_bf16 v[152:155], v[216:219], a[84:87], v[152:155]
ds_read_b64_tr_b16 v[202:203], v43 offset:3616
v_mfma_f32_16x16x32_bf16 v[156:159], v[220:223], a[80:83], v[156:159]
ds_read_b64_tr_b16 v[204:205], v43 offset:64
v_mfma_f32_16x16x32_bf16 v[160:163], v[220:223], a[84:87], v[160:163]
ds_read_b64_tr_b16 v[206:207], v43 offset:3648
buffer_load_dwordx4 a[124:127], v53, s[16:19], s62 offen offset:3072 sc1
v_mfma_f32_16x16x32_bf16 v[164:167], v[224:227], a[80:83], v[164:167]
ds_read_b64_tr_b16 v[208:209], v43 offset:96
v_mfma_f32_16x16x32_bf16 v[168:171], v[224:227], a[84:87], v[168:171]
ds_read_b64_tr_b16 v[210:211], v43 offset:3680
s_waitcnt vmcnt(8)
s_waitcnt lgkmcnt(8)
v_mfma_f32_16x16x32_bf16 v[140:143], v[228:231], a[88:91], v[140:143]
ds_read_b64_tr_b16 v[212:213], v43 offset:7168
s_add_u32 s44, s69, 32768
s_mov_b32 m0, s96
s_waitcnt lgkmcnt(15)
v_mfma_f32_16x16x32_bf16 v[144:147], v[228:231], a[92:95], v[144:147]
ds_read_b64_tr_b16 v[214:215], v43 offset:10752
buffer_load_dwordx4 v10, s[32:35], s44 offen offset:0 lds
v_mfma_f32_16x16x32_bf16 v[148:151], v[232:235], a[88:91], v[148:151]
ds_read_b64_tr_b16 v[216:217], v43 offset:7200
v_mfma_f32_16x16x32_bf16 v[152:155], v[232:235], a[92:95], v[152:155]
ds_read_b64_tr_b16 v[218:219], v43 offset:10784
v_mfma_f32_16x16x32_bf16 v[156:159], v[236:239], a[88:91], v[156:159]
ds_read_b64_tr_b16 v[220:221], v43 offset:7232
v_mfma_f32_16x16x32_bf16 v[160:163], v[236:239], a[92:95], v[160:163]
ds_read_b64_tr_b16 v[222:223], v43 offset:10816
buffer_load_dwordx4 v11, s[32:35], s44 offen offset:1024 lds
v_mfma_f32_16x16x32_bf16 v[164:167], v[240:243], a[88:91], v[164:167]
ds_read_b64_tr_b16 v[224:225], v43 offset:7264
v_mfma_f32_16x16x32_bf16 v[168:171], v[240:243], a[92:95], v[168:171]
ds_read_b64_tr_b16 v[226:227], v43 offset:10848
s_waitcnt vmcnt(8)
s_waitcnt lgkmcnt(8)
v_mfma_f32_16x16x32_bf16 v[140:143], v[196:199], a[96:99], v[140:143]
ds_read_b64_tr_b16 v[228:229], v43 offset:14336
v_mfma_f32_16x16x32_bf16 v[144:147], v[196:199], a[100:103], v[144:147]
ds_read_b64_tr_b16 v[230:231], v43 offset:17920
buffer_load_dwordx4 v12, s[32:35], s44 offen offset:2048 lds
v_mfma_f32_16x16x32_bf16 v[148:151], v[200:203], a[96:99], v[148:151]
ds_read_b64_tr_b16 v[232:233], v43 offset:14368
v_mfma_f32_16x16x32_bf16 v[152:155], v[200:203], a[100:103], v[152:155]
ds_read_b64_tr_b16 v[234:235], v43 offset:17952
v_mfma_f32_16x16x32_bf16 v[156:159], v[204:207], a[96:99], v[156:159]
ds_read_b64_tr_b16 v[236:237], v43 offset:14400
v_mfma_f32_16x16x32_bf16 v[160:163], v[204:207], a[100:103], v[160:163]
ds_read_b64_tr_b16 v[238:239], v43 offset:17984
buffer_load_dwordx4 v13, s[32:35], s44 offen offset:3072 lds
v_mfma_f32_16x16x32_bf16 v[164:167], v[208:211], a[96:99], v[164:167]
ds_read_b64_tr_b16 v[240:241], v43 offset:14432
v_mfma_f32_16x16x32_bf16 v[168:171], v[208:211], a[100:103], v[168:171]
ds_read_b64_tr_b16 v[242:243], v43 offset:18016
s_waitcnt vmcnt(8)
s_waitcnt lgkmcnt(8)
v_mfma_f32_16x16x32_bf16 v[140:143], v[212:215], a[104:107], v[140:143]
ds_read_b64_tr_b16 v[196:197], v43 offset:21504
s_add_u32 s44, s70, 32768
s_add_u32 m0, s48, 0
s_waitcnt lgkmcnt(15)
v_mfma_f32_16x16x32_bf16 v[144:147], v[212:215], a[108:111], v[144:147]
ds_read_b64_tr_b16 v[198:199], v43 offset:25088
buffer_load_dwordx4 v10, s[32:35], s44 offen offset:0 lds
v_mfma_f32_16x16x32_bf16 v[148:151], v[216:219], a[104:107], v[148:151]
ds_read_b64_tr_b16 v[200:201], v43 offset:21536
v_mfma_f32_16x16x32_bf16 v[152:155], v[216:219], a[108:111], v[152:155]
ds_read_b64_tr_b16 v[202:203], v43 offset:25120
v_mfma_f32_16x16x32_bf16 v[156:159], v[220:223], a[104:107], v[156:159]
ds_read_b64_tr_b16 v[204:205], v43 offset:21568
v_mfma_f32_16x16x32_bf16 v[160:163], v[220:223], a[108:111], v[160:163]
ds_read_b64_tr_b16 v[206:207], v43 offset:25152
buffer_load_dwordx4 v11, s[32:35], s44 offen offset:1024 lds
v_mfma_f32_16x16x32_bf16 v[164:167], v[224:227], a[104:107], v[164:167]
ds_read_b64_tr_b16 v[208:209], v43 offset:21600
v_mfma_f32_16x16x32_bf16 v[168:171], v[224:227], a[108:111], v[168:171]
ds_read_b64_tr_b16 v[210:211], v43 offset:25184
s_waitcnt vmcnt(8)
s_waitcnt lgkmcnt(8)
v_mfma_f32_16x16x32_bf16 v[140:143], v[228:231], a[112:115], v[140:143]
v_mfma_f32_16x16x32_bf16 v[144:147], v[228:231], a[116:119], v[144:147]
buffer_load_dwordx4 v12, s[32:35], s44 offen offset:2048 lds
v_mfma_f32_16x16x32_bf16 v[148:151], v[232:235], a[112:115], v[148:151]
v_mfma_f32_16x16x32_bf16 v[152:155], v[232:235], a[116:119], v[152:155]
v_mfma_f32_16x16x32_bf16 v[156:159], v[236:239], a[112:115], v[156:159]
v_mfma_f32_16x16x32_bf16 v[160:163], v[236:239], a[116:119], v[160:163]
buffer_load_dwordx4 v13, s[32:35], s44 offen offset:3072 lds
v_mfma_f32_16x16x32_bf16 v[164:167], v[240:243], a[112:115], v[164:167]
v_mfma_f32_16x16x32_bf16 v[168:171], v[240:243], a[116:119], v[168:171]
s_waitcnt vmcnt(8)
s_waitcnt lgkmcnt(0)
v_mfma_f32_16x16x32_bf16 v[140:143], v[196:199], a[120:123], v[140:143]
v_mfma_f32_16x16x32_bf16 v[144:147], v[196:199], a[124:127], v[144:147]
s_bitcmp1_b32 s1, 0
s_cselect_b32 s59, s65, s64
s_cselect_b32 s60, s64, s65
s_cselect_b32 s61, s67, s66
s_cselect_b32 s62, s66, s67
v_mfma_f32_16x16x32_bf16 v[148:151], v[200:203], a[120:123], v[148:151]
v_mfma_f32_16x16x32_bf16 v[152:155], v[200:203], a[124:127], v[152:155]
v_mfma_f32_16x16x32_bf16 v[156:159], v[204:207], a[120:123], v[156:159]
v_mfma_f32_16x16x32_bf16 v[160:163], v[204:207], a[124:127], v[160:163]
v_mfma_f32_16x16x32_bf16 v[164:167], v[208:211], a[120:123], v[164:167]
v_mfma_f32_16x16x32_bf16 v[168:171], v[208:211], a[124:127], v[168:171]
v_pk_mul_f32 v[140:141], v[140:141], v[62:63] op_sel_hi:[1,0]
v_exp_f32 v70, v140
v_exp_f32 v71, v141
v_pk_mul_f32 v[142:143], v[142:143], v[62:63] op_sel_hi:[1,0]
v_exp_f32 v74, v142
v_exp_f32 v75, v143
v_pk_fma_f32 v[68:69], v[70:71], -0.5, -1.0 op_sel_hi:[1,0,0]
v_pk_fma_f32 v[68:69], v[70:71], v[68:69], -1.0 op_sel_hi:[1,1,0]
v_rcp_f32 v68, v68
v_rcp_f32 v69, v69
v_pk_fma_f32 v[72:73], v[74:75], -0.5, -1.0 op_sel_hi:[1,0,0]
v_pk_fma_f32 v[72:73], v[74:75], v[72:73], -1.0 op_sel_hi:[1,1,0]
v_rcp_f32 v72, v72
v_rcp_f32 v73, v73
v_pk_fma_f32 v[140:141], v[68:69], v[140:141], v[140:141]
v_pk_fma_f32 v[142:143], v[72:73], v[142:143], v[142:143]
v_cvt_pk_bf16_f32 v140, v140, v141
v_cvt_pk_bf16_f32 v141, v142, v143
v_pk_mul_f32 v[148:149], v[148:149], v[62:63] op_sel_hi:[1,0]
v_exp_f32 v70, v148
v_exp_f32 v71, v149
v_pk_mul_f32 v[150:151], v[150:151], v[62:63] op_sel_hi:[1,0]
v_exp_f32 v74, v150
v_exp_f32 v75, v151
v_pk_fma_f32 v[68:69], v[70:71], -0.5, -1.0 op_sel_hi:[1,0,0]
v_pk_fma_f32 v[68:69], v[70:71], v[68:69], -1.0 op_sel_hi:[1,1,0]
v_rcp_f32 v68, v68
v_rcp_f32 v69, v69
v_pk_fma_f32 v[72:73], v[74:75], -0.5, -1.0 op_sel_hi:[1,0,0]
v_pk_fma_f32 v[72:73], v[74:75], v[72:73], -1.0 op_sel_hi:[1,1,0]
v_rcp_f32 v72, v72
v_rcp_f32 v73, v73
v_pk_fma_f32 v[148:149], v[68:69], v[148:149], v[148:149]
v_pk_fma_f32 v[150:151], v[72:73], v[150:151], v[150:151]
v_cvt_pk_bf16_f32 v142, v148, v149
v_cvt_pk_bf16_f32 v143, v150, v151
buffer_store_dwordx4 v[140:143], v5, s[16:19], s56 offen offset:0 sc1
v_pk_mul_f32 v[144:145], v[144:145], v[66:67] op_sel_hi:[1,0]
v_exp_f32 v70, v144
v_exp_f32 v71, v145
v_pk_mul_f32 v[146:147], v[146:147], v[66:67] op_sel_hi:[1,0]
v_exp_f32 v74, v146
v_exp_f32 v75, v147
v_pk_fma_f32 v[68:69], v[70:71], -0.5, -1.0 op_sel_hi:[1,0,0]
v_pk_fma_f32 v[68:69], v[70:71], v[68:69], -1.0 op_sel_hi:[1,1,0]
v_rcp_f32 v68, v68
v_rcp_f32 v69, v69
v_pk_fma_f32 v[72:73], v[74:75], -0.5, -1.0 op_sel_hi:[1,0,0]
v_pk_fma_f32 v[72:73], v[74:75], v[72:73], -1.0 op_sel_hi:[1,1,0]
v_rcp_f32 v72, v72
v_rcp_f32 v73, v73
v_pk_fma_f32 v[144:145], v[68:69], v[144:145], v[144:145]
v_pk_fma_f32 v[146:147], v[72:73], v[146:147], v[146:147]
v_cvt_pk_bf16_f32 v144, v144, v145
v_cvt_pk_bf16_f32 v145, v146, v147
v_pk_mul_f32 v[152:153], v[152:153], v[66:67] op_sel_hi:[1,0]
v_exp_f32 v70, v152
v_exp_f32 v71, v153
v_pk_mul_f32 v[154:155], v[154:155], v[66:67] op_sel_hi:[1,0]
v_exp_f32 v74, v154
v_exp_f32 v75, v155
v_pk_fma_f32 v[68:69], v[70:71], -0.5, -1.0 op_sel_hi:[1,0,0]
v_pk_fma_f32 v[68:69], v[70:71], v[68:69], -1.0 op_sel_hi:[1,1,0]
v_rcp_f32 v68, v68
v_rcp_f32 v69, v69
v_pk_fma_f32 v[72:73], v[74:75], -0.5, -1.0 op_sel_hi:[1,0,0]
v_pk_fma_f32 v[72:73], v[74:75], v[72:73], -1.0 op_sel_hi:[1,1,0]
v_rcp_f32 v72, v72
v_rcp_f32 v73, v73
v_pk_fma_f32 v[152:153], v[68:69], v[152:153], v[152:153]
v_pk_fma_f32 v[154:155], v[72:73], v[154:155], v[154:155]
v_cvt_pk_bf16_f32 v146, v152, v153
v_cvt_pk_bf16_f32 v147, v154, v155
buffer_store_dwordx4 v[144:147], v5, s[16:19], s57 offen offset:0 sc1
v_pk_mul_f32 v[156:157], v[156:157], v[62:63] op_sel_hi:[1,0]
v_exp_f32 v70, v156
v_exp_f32 v71, v157
v_pk_mul_f32 v[158:159], v[158:159], v[62:63] op_sel_hi:[1,0]
v_exp_f32 v74, v158
v_exp_f32 v75, v159
v_pk_fma_f32 v[68:69], v[70:71], -0.5, -1.0 op_sel_hi:[1,0,0]
v_pk_fma_f32 v[68:69], v[70:71], v[68:69], -1.0 op_sel_hi:[1,1,0]
v_rcp_f32 v68, v68
v_rcp_f32 v69, v69
v_pk_fma_f32 v[72:73], v[74:75], -0.5, -1.0 op_sel_hi:[1,0,0]
v_pk_fma_f32 v[72:73], v[74:75], v[72:73], -1.0 op_sel_hi:[1,1,0]
v_rcp_f32 v72, v72
v_rcp_f32 v73, v73
v_pk_fma_f32 v[156:157], v[68:69], v[156:157], v[156:157]
v_pk_fma_f32 v[158:159], v[72:73], v[158:159], v[158:159]
v_cvt_pk_bf16_f32 v156, v156, v157
v_cvt_pk_bf16_f32 v157, v158, v159
v_pk_mul_f32 v[164:165], v[164:165], v[62:63] op_sel_hi:[1,0]
v_exp_f32 v70, v164
v_exp_f32 v71, v165
v_pk_mul_f32 v[166:167], v[166:167], v[62:63] op_sel_hi:[1,0]
v_exp_f32 v74, v166
v_exp_f32 v75, v167
v_pk_fma_f32 v[68:69], v[70:71], -0.5, -1.0 op_sel_hi:[1,0,0]
v_pk_fma_f32 v[68:69], v[70:71], v[68:69], -1.0 op_sel_hi:[1,1,0]
v_rcp_f32 v68, v68
v_rcp_f32 v69, v69
v_pk_fma_f32 v[72:73], v[74:75], -0.5, -1.0 op_sel_hi:[1,0,0]
v_pk_fma_f32 v[72:73], v[74:75], v[72:73], -1.0 op_sel_hi:[1,1,0]
v_rcp_f32 v72, v72
v_rcp_f32 v73, v73
v_pk_fma_f32 v[164:165], v[68:69], v[164:165], v[164:165]
v_pk_fma_f32 v[166:167], v[72:73], v[166:167], v[166:167]
ds_read_b64_tr_b16 v[196:197], v44 offset:128
v_cvt_pk_bf16_f32 v158, v164, v165
ds_read_b64_tr_b16 v[198:199], v44 offset:3712
v_cvt_pk_bf16_f32 v159, v166, v167
ds_read_b64_tr_b16 v[200:201], v44 offset:160
buffer_store_dwordx4 v[156:159], v5, s[16:19], s56 offen offset:1024 sc1
ds_read_b64_tr_b16 v[202:203], v44 offset:3744
v_pk_mul_f32 v[160:161], v[160:161], v[66:67] op_sel_hi:[1,0]
ds_read_b64_tr_b16 v[204:205], v44 offset:192
v_exp_f32 v70, v160
ds_read_b64_tr_b16 v[206:207], v44 offset:3776
v_exp_f32 v71, v161
ds_read_b64_tr_b16 v[208:209], v44 offset:7296
v_pk_mul_f32 v[162:163], v[162:163], v[66:67] op_sel_hi:[1,0]
ds_read_b64_tr_b16 v[210:211], v44 offset:10880
v_exp_f32 v74, v162
ds_read_b64_tr_b16 v[212:213], v44 offset:7328
v_exp_f32 v75, v163
ds_read_b64_tr_b16 v[214:215], v44 offset:10912
v_pk_fma_f32 v[68:69], v[70:71], -0.5, -1.0 op_sel_hi:[1,0,0]
ds_read_b64_tr_b16 v[216:217], v44 offset:7360
v_pk_fma_f32 v[68:69], v[70:71], v[68:69], -1.0 op_sel_hi:[1,1,0]
ds_read_b64_tr_b16 v[218:219], v44 offset:10944
v_rcp_f32 v68, v68
ds_read_b64_tr_b16 v[220:221], v44 offset:14464
v_rcp_f32 v69, v69
ds_read_b64_tr_b16 v[222:223], v44 offset:18048
v_pk_fma_f32 v[72:73], v[74:75], -0.5, -1.0 op_sel_hi:[1,0,0]
ds_read_b64_tr_b16 v[224:225], v44 offset:14496
v_pk_fma_f32 v[72:73], v[74:75], v[72:73], -1.0 op_sel_hi:[1,1,0]
ds_read_b64_tr_b16 v[226:227], v44 offset:18080
v_rcp_f32 v72, v72
ds_read_b64_tr_b16 v[228:229], v44 offset:14528
v_rcp_f32 v73, v73
ds_read_b64_tr_b16 v[230:231], v44 offset:18112
v_pk_fma_f32 v[160:161], v[68:69], v[160:161], v[160:161]
v_pk_fma_f32 v[162:163], v[72:73], v[162:163], v[162:163]
v_cvt_pk_bf16_f32 v160, v160, v161
v_cvt_pk_bf16_f32 v161, v162, v163
v_pk_mul_f32 v[168:169], v[168:169], v[66:67] op_sel_hi:[1,0]
v_exp_f32 v70, v168
v_exp_f32 v71, v169
v_pk_mul_f32 v[170:171], v[170:171], v[66:67] op_sel_hi:[1,0]
v_exp_f32 v74, v170
v_exp_f32 v75, v171
v_pk_fma_f32 v[68:69], v[70:71], -0.5, -1.0 op_sel_hi:[1,0,0]
v_pk_fma_f32 v[68:69], v[70:71], v[68:69], -1.0 op_sel_hi:[1,1,0]
v_rcp_f32 v68, v68
v_rcp_f32 v69, v69
v_pk_fma_f32 v[72:73], v[74:75], -0.5, -1.0 op_sel_hi:[1,0,0]
v_pk_fma_f32 v[72:73], v[74:75], v[72:73], -1.0 op_sel_hi:[1,1,0]
v_rcp_f32 v72, v72
v_rcp_f32 v73, v73
v_pk_fma_f32 v[168:169], v[68:69], v[168:169], v[168:169]
v_pk_fma_f32 v[170:171], v[72:73], v[170:171], v[170:171]
v_cvt_pk_bf16_f32 v162, v168, v169
v_cvt_pk_bf16_f32 v163, v170, v171
buffer_store_dwordx4 v[160:163], v5, s[16:19], s57 offen offset:1024 sc1
s_waitcnt lgkmcnt(12)
v_mfma_f32_16x16x32_bf16 v[172:175], v[196:199], a[0:3], v[172:175]
ds_read_b64_tr_b16 v[232:233], v44 offset:21632
s_add_u32 s44, s71, 32768
s_add_u32 m0, s48, 4096
s_waitcnt lgkmcnt(15)
v_mfma_f32_16x16x32_bf16 v[176:179], v[196:199], a[4:7], v[176:179]
ds_read_b64_tr_b16 v[234:235], v44 offset:25216
buffer_load_dwordx4 v10, s[32:35], s44 offen offset:0 lds
v_mfma_f32_16x16x32_bf16 v[180:183], v[200:203], a[0:3], v[180:183]
ds_read_b64_tr_b16 v[236:237], v44 offset:21664
v_mfma_f32_16x16x32_bf16 v[184:187], v[200:203], a[4:7], v[184:187]
ds_read_b64_tr_b16 v[238:239], v44 offset:25248
v_mfma_f32_16x16x32_bf16 v[188:191], v[204:207], a[0:3], v[188:191]
ds_read_b64_tr_b16 v[240:241], v44 offset:21696
v_mfma_f32_16x16x32_bf16 v[192:195], v[204:207], a[4:7], v[192:195]
ds_read_b64_tr_b16 v[242:243], v44 offset:25280
buffer_load_dwordx4 v11, s[32:35], s44 offen offset:1024 lds
s_waitcnt lgkmcnt(12)
v_mfma_f32_16x16x32_bf16 v[172:175], v[208:211], a[8:11], v[172:175]
ds_read_b64_tr_b16 v[196:197], v42 offset:128
v_mfma_f32_16x16x32_bf16 v[176:179], v[208:211], a[12:15], v[176:179]
ds_read_b64_tr_b16 v[198:199], v42 offset:3712
v_mfma_f32_16x16x32_bf16 v[180:183], v[212:215], a[8:11], v[180:183]
ds_read_b64_tr_b16 v[200:201], v42 offset:160
v_mfma_f32_16x16x32_bf16 v[184:187], v[212:215], a[12:15], v[184:187]
ds_read_b64_tr_b16 v[202:203], v42 offset:3744
buffer_load_dwordx4 v12, s[32:35], s44 offen offset:2048 lds
v_mfma_f32_16x16x32_bf16 v[188:191], v[216:219], a[8:11], v[188:191]
ds_read_b64_tr_b16 v[204:205], v42 offset:192
v_mfma_f32_16x16x32_bf16 v[192:195], v[216:219], a[12:15], v[192:195]
ds_read_b64_tr_b16 v[206:207], v42 offset:3776
s_waitcnt lgkmcnt(12)
v_mfma_f32_16x16x32_bf16 v[172:175], v[220:223], a[16:19], v[172:175]
ds_read_b64_tr_b16 v[208:209], v42 offset:7296
v_mfma_f32_16x16x32_bf16 v[176:179], v[220:223], a[20:23], v[176:179]
ds_read_b64_tr_b16 v[210:211], v42 offset:10880
buffer_load_dwordx4 v13, s[32:35], s44 offen offset:3072 lds
v_mfma_f32_16x16x32_bf16 v[180:183], v[224:227], a[16:19], v[180:183]
ds_read_b64_tr_b16 v[212:213], v42 offset:7328
v_mfma_f32_16x16x32_bf16 v[184:187], v[224:227], a[20:23], v[184:187]
ds_read_b64_tr_b16 v[214:215], v42 offset:10912
v_mfma_f32_16x16x32_bf16 v[188:191], v[228:231], a[16:19], v[188:191]
ds_read_b64_tr_b16 v[216:217], v42 offset:7360
s_waitcnt vmcnt(12)
ds_read_b64_tr_b16 a[208:209], v56 offset:0
v_mfma_f32_16x16x32_bf16 v[192:195], v[228:231], a[20:23], v[192:195]
ds_read_b64_tr_b16 v[218:219], v42 offset:10944
ds_read_b64_tr_b16 a[210:211], v56 offset:2048
s_waitcnt lgkmcnt(14)
v_mfma_f32_16x16x32_bf16 v[172:175], v[232:235], a[24:27], v[172:175]
ds_read_b64_tr_b16 v[220:221], v42 offset:14464
ds_read_b64_tr_b16 a[212:213], v57 offset:0
v_mfma_f32_16x16x32_bf16 v[176:179], v[232:235], a[28:31], v[176:179]
ds_read_b64_tr_b16 v[222:223], v42 offset:18048
ds_read_b64_tr_b16 a[214:215], v57 offset:2048
v_mfma_f32_16x16x32_bf16 v[180:183], v[236:239], a[24:27], v[180:183]
ds_read_b64_tr_b16 v[224:225], v42 offset:14496
ds_read_b64_tr_b16 a[216:217], v58 offset:0
v_mfma_f32_16x16x32_bf16 v[184:187], v[236:239], a[28:31], v[184:187]
ds_read_b64_tr_b16 v[226:227], v42 offset:18080
ds_read_b64_tr_b16 a[218:219], v58 offset:2048
v_mfma_f32_16x16x32_bf16 v[188:191], v[240:243], a[24:27], v[188:191]
ds_read_b64_tr_b16 v[228:229], v42 offset:14528
ds_read_b64_tr_b16 a[220:221], v59 offset:0
v_mfma_f32_16x16x32_bf16 v[192:195], v[240:243], a[28:31], v[192:195]
ds_read_b64_tr_b16 v[230:231], v42 offset:18112
ds_read_b64_tr_b16 a[222:223], v59 offset:2048
s_waitcnt lgkmcnt(15)
v_mfma_f32_16x16x32_bf16 v[172:175], v[196:199], a[32:35], v[172:175]
ds_read_b64_tr_b16 v[232:233], v42 offset:21632
s_waitcnt vmcnt(8)
ds_read_b64_tr_b16 a[224:225], v14 offset:32768
v_mfma_f32_16x16x32_bf16 v[176:179], v[196:199], a[36:39], v[176:179]
ds_read_b64_tr_b16 v[234:235], v42 offset:25216
ds_read_b64_tr_b16 a[226:227], v14 offset:34816
v_mfma_f32_16x16x32_bf16 v[180:183], v[200:203], a[32:35], v[180:183]
ds_read_b64_tr_b16 v[236:237], v42 offset:21664
ds_read_b64_tr_b16 a[228:229], v15 offset:32768
v_mfma_f32_16x16x32_bf16 v[184:187], v[200:203], a[36:39], v[184:187]
ds_read_b64_tr_b16 v[238:239], v42 offset:25248
ds_read_b64_tr_b16 a[230:231], v15 offset:34816
v_mfma_f32_16x16x32_bf16 v[188:191], v[204:207], a[32:35], v[188:191]
ds_read_b64_tr_b16 v[240:241], v42 offset:21696
ds_read_b64_tr_b16 a[232:233], v16 offset:32768
v_mfma_f32_16x16x32_bf16 v[192:195], v[204:207], a[36:39], v[192:195]
ds_read_b64_tr_b16 v[242:243], v42 offset:25280
ds_read_b64_tr_b16 a[234:235], v16 offset:34816
s_waitcnt lgkmcnt(15)
v_mfma_f32_16x16x32_bf16 v[172:175], v[208:211], a[40:43], v[172:175]
ds_read_b64_tr_b16 v[196:197], v42 offset:32896
ds_read_b64_tr_b16 a[236:237], v17 offset:32768
v_mfma_f32_16x16x32_bf16 v[176:179], v[208:211], a[44:47], v[176:179]
ds_read_b64_tr_b16 v[198:199], v42 offset:36480
ds_read_b64_tr_b16 a[238:239], v17 offset:34816
v_mfma_f32_16x16x32_bf16 v[180:183], v[212:215], a[40:43], v[180:183]
ds_read_b64_tr_b16 v[200:201], v42 offset:32928
s_add_u32 s44, s68, 65536
s_mov_b32 m0, s96
s_waitcnt lgkmcnt(15)
v_mfma_f32_16x16x32_bf16 v[184:187], v[212:215], a[44:47], v[184:187]
ds_read_b64_tr_b16 v[202:203], v42 offset:36512
buffer_load_dwordx4 v10, s[32:35], s44 offen offset:0 lds
v_mfma_f32_16x16x32_bf16 v[188:191], v[216:219], a[40:43], v[188:191]
ds_read_b64_tr_b16 v[204:205], v42 offset:32960
v_mfma_f32_16x16x32_bf16 v[192:195], v[216:219], a[44:47], v[192:195]
ds_read_b64_tr_b16 v[206:207], v42 offset:36544
s_waitcnt lgkmcnt(15)
v_mfma_f32_16x16x32_bf16 v[172:175], v[220:223], a[48:51], v[172:175]
ds_read_b64_tr_b16 v[208:209], v42 offset:40064
v_mfma_f32_16x16x32_bf16 v[176:179], v[220:223], a[52:55], v[176:179]
ds_read_b64_tr_b16 v[210:211], v42 offset:43648
buffer_load_dwordx4 v11, s[32:35], s44 offen offset:1024 lds
v_mfma_f32_16x16x32_bf16 v[180:183], v[224:227], a[48:51], v[180:183]
ds_read_b64_tr_b16 v[212:213], v42 offset:40096
v_mfma_f32_16x16x32_bf16 v[184:187], v[224:227], a[52:55], v[184:187]
ds_read_b64_tr_b16 v[214:215], v42 offset:43680
v_mfma_f32_16x16x32_bf16 v[188:191], v[228:231], a[48:51], v[188:191]
ds_read_b64_tr_b16 v[216:217], v42 offset:40128
v_mfma_f32_16x16x32_bf16 v[192:195], v[228:231], a[52:55], v[192:195]
ds_read_b64_tr_b16 v[218:219], v42 offset:43712
buffer_load_dwordx4 v12, s[32:35], s44 offen offset:2048 lds
s_waitcnt lgkmcnt(15)
v_mfma_f32_16x16x32_bf16 v[172:175], v[232:235], a[56:59], v[172:175]
ds_read_b64_tr_b16 v[220:221], v42 offset:47232
v_mfma_f32_16x16x32_bf16 v[176:179], v[232:235], a[60:63], v[176:179]
ds_read_b64_tr_b16 v[222:223], v42 offset:50816
s_waitcnt vmcnt(7)
s_mov_b64 exec, 1
buffer_store_dword v7, off, s[16:19], s58 sc1
s_mov_b64 exec, -1
s_add_u32 s58, s58, 0x20000
v_mfma_f32_16x16x32_bf16 v[180:183], v[236:239], a[56:59], v[180:183]
ds_read_b64_tr_b16 v[224:225], v42 offset:47264
v_mfma_f32_16x16x32_bf16 v[184:187], v[236:239], a[60:63], v[184:187]
ds_read_b64_tr_b16 v[226:227], v42 offset:50848
buffer_load_dwordx4 v13, s[32:35], s44 offen offset:3072 lds
v_mfma_f32_16x16x32_bf16 v[188:191], v[240:243], a[56:59], v[188:191]
ds_read_b64_tr_b16 v[228:229], v42 offset:47296
v_mfma_f32_16x16x32_bf16 v[192:195], v[240:243], a[60:63], v[192:195]
ds_read_b64_tr_b16 v[230:231], v42 offset:50880
s_waitcnt lgkmcnt(12)
v_mfma_f32_16x16x32_bf16 v[172:175], v[196:199], a[64:67], v[172:175]
ds_read_b64_tr_b16 v[232:233], v42 offset:54400
s_add_u32 s44, s69, 65536
s_add_u32 m0, s48, 0
s_waitcnt lgkmcnt(15)
v_mfma_f32_16x16x32_bf16 v[176:179], v[196:199], a[68:71], v[176:179]
ds_read_b64_tr_b16 v[234:235], v42 offset:57984
buffer_load_dwordx4 v10, s[32:35], s44 offen offset:0 lds
v_mfma_f32_16x16x32_bf16 v[180:183], v[200:203], a[64:67], v[180:183]
ds_read_b64_tr_b16 v[236:237], v42 offset:54432
v_mfma_f32_16x16x32_bf16 v[184:187], v[200:203], a[68:71], v[184:187]
ds_read_b64_tr_b16 v[238:239], v42 offset:58016
v_mfma_f32_16x16x32_bf16 v[188:191], v[204:207], a[64:67], v[188:191]
ds_read_b64_tr_b16 v[240:241], v42 offset:54464
v_mfma_f32_16x16x32_bf16 v[192:195], v[204:207], a[68:71], v[192:195]
ds_read_b64_tr_b16 v[242:243], v42 offset:58048
buffer_load_dwordx4 v11, s[32:35], s44 offen offset:1024 lds
s_waitcnt lgkmcnt(12)
v_mfma_f32_16x16x32_bf16 v[172:175], v[208:211], a[72:75], v[172:175]
ds_read_b64_tr_b16 v[196:197], v43 offset:128
v_mfma_f32_16x16x32_bf16 v[176:179], v[208:211], a[76:79], v[176:179]
ds_read_b64_tr_b16 v[198:199], v43 offset:3712
v_mfma_f32_16x16x32_bf16 v[180:183], v[212:215], a[72:75], v[180:183]
ds_read_b64_tr_b16 v[200:201], v43 offset:160
v_mfma_f32_16x16x32_bf16 v[184:187], v[212:215], a[76:79], v[184:187]
ds_read_b64_tr_b16 v[202:203], v43 offset:3744
buffer_load_dwordx4 v12, s[32:35], s44 offen offset:2048 lds
v_mfma_f32_16x16x32_bf16 v[188:191], v[216:219], a[72:75], v[188:191]
ds_read_b64_tr_b16 v[204:205], v43 offset:192
v_mfma_f32_16x16x32_bf16 v[192:195], v[216:219], a[76:79], v[192:195]
ds_read_b64_tr_b16 v[206:207], v43 offset:3776
s_waitcnt lgkmcnt(12)
v_mfma_f32_16x16x32_bf16 v[172:175], v[220:223], a[80:83], v[172:175]
ds_read_b64_tr_b16 v[208:209], v43 offset:7296
v_mfma_f32_16x16x32_bf16 v[176:179], v[220:223], a[84:87], v[176:179]
ds_read_b64_tr_b16 v[210:211], v43 offset:10880
buffer_load_dwordx4 v13, s[32:35], s44 offen offset:3072 lds
v_mfma_f32_16x16x32_bf16 v[180:183], v[224:227], a[80:83], v[180:183]
ds_read_b64_tr_b16 v[212:213], v43 offset:7328
v_mfma_f32_16x16x32_bf16 v[184:187], v[224:227], a[84:87], v[184:187]
ds_read_b64_tr_b16 v[214:215], v43 offset:10912
v_mfma_f32_16x16x32_bf16 v[188:191], v[228:231], a[80:83], v[188:191]
ds_read_b64_tr_b16 v[216:217], v43 offset:7360
s_waitcnt vmcnt(9)
ds_read_b64_tr_b16 a[240:241], v14 offset:36864
v_mfma_f32_16x16x32_bf16 v[192:195], v[228:231], a[84:87], v[192:195]
ds_read_b64_tr_b16 v[218:219], v43 offset:10944
ds_read_b64_tr_b16 a[242:243], v14 offset:38912
s_waitcnt lgkmcnt(14)
v_mfma_f32_16x16x32_bf16 v[172:175], v[232:235], a[88:91], v[172:175]
ds_read_b64_tr_b16 v[220:221], v43 offset:14464
ds_read_b64_tr_b16 a[244:245], v15 offset:36864
v_mfma_f32_16x16x32_bf16 v[176:179], v[232:235], a[92:95], v[176:179]
ds_read_b64_tr_b16 v[222:223], v43 offset:18048
ds_read_b64_tr_b16 a[246:247], v15 offset:38912
v_mfma_f32_16x16x32_bf16 v[180:183], v[236:239], a[88:91], v[180:183]
ds_read_b64_tr_b16 v[224:225], v43 offset:14496
ds_read_b64_tr_b16 a[248:249], v16 offset:36864
v_mfma_f32_16x16x32_bf16 v[184:187], v[236:239], a[92:95], v[184:187]
ds_read_b64_tr_b16 v[226:227], v43 offset:18080
ds_read_b64_tr_b16 a[250:251], v16 offset:38912
v_mfma_f32_16x16x32_bf16 v[188:191], v[240:243], a[88:91], v[188:191]
ds_read_b64_tr_b16 v[228:229], v43 offset:14528
ds_read_b64_tr_b16 a[252:253], v17 offset:36864
v_mfma_f32_16x16x32_bf16 v[192:195], v[240:243], a[92:95], v[192:195]
ds_read_b64_tr_b16 v[230:231], v43 offset:18112
ds_read_b64_tr_b16 a[254:255], v17 offset:38912
s_waitcnt lgkmcnt(15)
v_mfma_f32_16x16x32_bf16 v[172:175], v[196:199], a[96:99], v[172:175]
ds_read_b64_tr_b16 v[232:233], v43 offset:21632
s_add_u32 s44, s70, 65536
s_add_u32 m0, s48, 4096
s_waitcnt lgkmcnt(1)
v_mfma_f32_16x16x32_bf16 v[176:179], v[196:199], a[100:103], v[176:179]
ds_read_b64_tr_b16 v[234:235], v43 offset:25216
buffer_load_dwordx4 v10, s[32:35], s44 offen offset:0 lds
v_mfma_f32_16x16x32_bf16 v[180:183], v[200:203], a[96:99], v[180:183]
ds_read_b64_tr_b16 v[236:237], v43 offset:21664
v_mfma_f32_16x16x32_bf16 v[184:187], v[200:203], a[100:103], v[184:187]
ds_read_b64_tr_b16 v[238:239], v43 offset:25248
v_mfma_f32_16x16x32_bf16 v[188:191], v[204:207], a[96:99], v[188:191]
ds_read_b64_tr_b16 v[240:241], v43 offset:21696
v_mfma_f32_16x16x32_bf16 v[192:195], v[204:207], a[100:103], v[192:195]
ds_read_b64_tr_b16 v[242:243], v43 offset:25280
buffer_load_dwordx4 v11, s[32:35], s44 offen offset:1024 lds
s_waitcnt lgkmcnt(15)
v_mfma_f32_16x16x32_bf16 v[172:175], v[208:211], a[104:107], v[172:175]
v_mfma_f32_16x16x32_bf16 v[176:179], v[208:211], a[108:111], v[176:179]
v_mfma_f32_16x16x32_bf16 v[180:183], v[212:215], a[104:107], v[180:183]
v_mfma_f32_16x16x32_bf16 v[184:187], v[212:215], a[108:111], v[184:187]
buffer_load_dwordx4 v12, s[32:35], s44 offen offset:2048 lds
v_mfma_f32_16x16x32_bf16 v[188:191], v[216:219], a[104:107], v[188:191]
v_mfma_f32_16x16x32_bf16 v[192:195], v[216:219], a[108:111], v[192:195]
s_waitcnt lgkmcnt(7)
v_mfma_f32_16x16x32_bf16 v[172:175], v[220:223], a[112:115], v[172:175]
v_mfma_f32_16x16x32_bf16 v[176:179], v[220:223], a[116:119], v[176:179]
buffer_load_dwordx4 v13, s[32:35], s44 offen offset:3072 lds
v_mfma_f32_16x16x32_bf16 v[180:183], v[224:227], a[112:115], v[180:183]
v_mfma_f32_16x16x32_bf16 v[184:187], v[224:227], a[116:119], v[184:187]
v_mfma_f32_16x16x32_bf16 v[188:191], v[228:231], a[112:115], v[188:191]
v_mfma_f32_16x16x32_bf16 v[192:195], v[228:231], a[116:119], v[192:195]
s_waitcnt lgkmcnt(0)
v_mfma_f32_16x16x32_bf16 v[172:175], v[232:235], a[120:123], v[172:175]
v_mfma_f32_16x16x32_bf16 v[176:179], v[232:235], a[124:127], v[176:179]
v_mfma_f32_16x16x32_bf16 v[180:183], v[236:239], a[120:123], v[180:183]
v_mfma_f32_16x16x32_bf16 v[184:187], v[236:239], a[124:127], v[184:187]
v_mfma_f32_16x16x32_bf16 v[188:191], v[240:243], a[120:123], v[188:191]
v_mfma_f32_16x16x32_bf16 v[192:195], v[240:243], a[124:127], v[192:195]
s_nop 2
v_pk_mul_f32 v[172:173], v[172:173], v[62:63] op_sel_hi:[1,0]
s_waitcnt vmcnt(8)
ds_read_b64_tr_b16 v[84:85], v56 offset:0
v_exp_f32 v70, v172
ds_read_b64_tr_b16 v[86:87], v56 offset:2048
v_exp_f32 v71, v173
ds_read_b64_tr_b16 v[88:89], v57 offset:0
v_pk_mul_f32 v[174:175], v[174:175], v[62:63] op_sel_hi:[1,0]
ds_read_b64_tr_b16 v[90:91], v57 offset:2048
v_exp_f32 v74, v174
ds_read_b64_tr_b16 v[92:93], v58 offset:0
v_exp_f32 v75, v175
ds_read_b64_tr_b16 v[94:95], v58 offset:2048
v_pk_fma_f32 v[68:69], v[70:71], -0.5, -1.0 op_sel_hi:[1,0,0]
ds_read_b64_tr_b16 v[96:97], v59 offset:0
v_pk_fma_f32 v[68:69], v[70:71], v[68:69], -1.0 op_sel_hi:[1,1,0]
ds_read_b64_tr_b16 v[98:99], v59 offset:2048
v_rcp_f32 v68, v68
s_waitcnt vmcnt(4)
ds_read_b64_tr_b16 v[100:101], v14 offset:32768
v_rcp_f32 v69, v69
ds_read_b64_tr_b16 v[102:103], v14 offset:34816
v_pk_fma_f32 v[72:73], v[74:75], -0.5, -1.0 op_sel_hi:[1,0,0]
ds_read_b64_tr_b16 v[104:105], v15 offset:32768
v_pk_fma_f32 v[72:73], v[74:75], v[72:73], -1.0 op_sel_hi:[1,1,0]
ds_read_b64_tr_b16 v[106:107], v15 offset:34816
v_rcp_f32 v72, v72
ds_read_b64_tr_b16 v[108:109], v16 offset:32768
v_rcp_f32 v73, v73
ds_read_b64_tr_b16 v[110:111], v16 offset:34816
v_pk_fma_f32 v[172:173], v[68:69], v[172:173], v[172:173]
ds_read_b64_tr_b16 v[112:113], v17 offset:32768
v_pk_fma_f32 v[174:175], v[72:73], v[174:175], v[174:175]
ds_read_b64_tr_b16 v[114:115], v17 offset:34816
v_cvt_pk_bf16_f32 v172, v172, v173
s_add_u32 s44, s71, 65536
s_mov_b32 m0, s96
s_waitcnt lgkmcnt(8)
v_cvt_pk_bf16_f32 v173, v174, v175
buffer_load_dwordx4 v10, s[32:35], s44 offen offset:0 lds
v_pk_mul_f32 v[180:181], v[180:181], v[62:63] op_sel_hi:[1,0]
v_exp_f32 v70, v180
v_exp_f32 v71, v181
v_pk_mul_f32 v[182:183], v[182:183], v[62:63] op_sel_hi:[1,0]
v_exp_f32 v74, v182
buffer_load_dwordx4 v11, s[32:35], s44 offen offset:1024 lds
v_exp_f32 v75, v183
v_pk_fma_f32 v[68:69], v[70:71], -0.5, -1.0 op_sel_hi:[1,0,0]
v_pk_fma_f32 v[68:69], v[70:71], v[68:69], -1.0 op_sel_hi:[1,1,0]
v_rcp_f32 v68, v68
v_rcp_f32 v69, v69
buffer_load_dwordx4 v12, s[32:35], s44 offen offset:2048 lds
v_pk_fma_f32 v[72:73], v[74:75], -0.5, -1.0 op_sel_hi:[1,0,0]
v_pk_fma_f32 v[72:73], v[74:75], v[72:73], -1.0 op_sel_hi:[1,1,0]
v_rcp_f32 v72, v72
v_rcp_f32 v73, v73
v_pk_fma_f32 v[180:181], v[68:69], v[180:181], v[180:181]
buffer_load_dwordx4 v13, s[32:35], s44 offen offset:3072 lds
v_pk_fma_f32 v[182:183], v[72:73], v[182:183], v[182:183]
v_cvt_pk_bf16_f32 v174, v180, v181
v_cvt_pk_bf16_f32 v175, v182, v183
buffer_store_dwordx4 v[172:175], v5, s[16:19], s56 offen offset:2048 sc1
s_add_u32 s44, s68, 98304
s_add_u32 m0, s48, 0
s_waitcnt lgkmcnt(0)
v_pk_mul_f32 v[176:177], v[176:177], v[66:67] op_sel_hi:[1,0]
buffer_load_dwordx4 v10, s[32:35], s44 offen offset:0 lds
v_exp_f32 v70, v176
v_exp_f32 v71, v177
v_pk_mul_f32 v[178:179], v[178:179], v[66:67] op_sel_hi:[1,0]
v_exp_f32 v74, v178
v_exp_f32 v75, v179
buffer_load_dwordx4 v11, s[32:35], s44 offen offset:1024 lds
v_pk_fma_f32 v[68:69], v[70:71], -0.5, -1.0 op_sel_hi:[1,0,0]
v_pk_fma_f32 v[68:69], v[70:71], v[68:69], -1.0 op_sel_hi:[1,1,0]
v_rcp_f32 v68, v68
v_rcp_f32 v69, v69
s_add_u32 s44, s69, 81920
v_pk_fma_f32 v[72:73], v[74:75], -0.5, -1.0 op_sel_hi:[1,0,0]
buffer_load_dwordx4 v12, s[32:35], s44 offen offset:2048 lds
v_pk_fma_f32 v[72:73], v[74:75], v[72:73], -1.0 op_sel_hi:[1,1,0]
v_rcp_f32 v72, v72
v_rcp_f32 v73, v73
s_mov_b64 exec, 0xff
buffer_load_dword v8, v51, s[16:19], s97 offen offset:0 sc1
s_mov_b64 exec, -1
v_pk_fma_f32 v[176:177], v[68:69], v[176:177], v[176:177]
v_pk_fma_f32 v[178:179], v[72:73], v[178:179], v[178:179]
buffer_load_dwordx4 v13, s[32:35], s44 offen offset:3072 lds
v_cvt_pk_bf16_f32 v176, v176, v177
v_cvt_pk_bf16_f32 v177, v178, v179
v_pk_mul_f32 v[184:185], v[184:185], v[66:67] op_sel_hi:[1,0]
v_exp_f32 v70, v184
v_exp_f32 v71, v185
v_pk_mul_f32 v[186:187], v[186:187], v[66:67] op_sel_hi:[1,0]
v_exp_f32 v74, v186
v_exp_f32 v75, v187
v_pk_fma_f32 v[68:69], v[70:71], -0.5, -1.0 op_sel_hi:[1,0,0]
v_pk_fma_f32 v[68:69], v[70:71], v[68:69], -1.0 op_sel_hi:[1,1,0]
v_rcp_f32 v68, v68
v_rcp_f32 v69, v69
v_pk_fma_f32 v[72:73], v[74:75], -0.5, -1.0 op_sel_hi:[1,0,0]
v_pk_fma_f32 v[72:73], v[74:75], v[72:73], -1.0 op_sel_hi:[1,1,0]
v_rcp_f32 v72, v72
v_rcp_f32 v73, v73
v_pk_fma_f32 v[184:185], v[68:69], v[184:185], v[184:185]
s_waitcnt vmcnt(10)
ds_read_b64_tr_b16 v[116:117], v14 offset:36864
v_pk_fma_f32 v[186:187], v[72:73], v[186:187], v[186:187]
ds_read_b64_tr_b16 v[118:119], v14 offset:38912
v_cvt_pk_bf16_f32 v178, v184, v185
ds_read_b64_tr_b16 v[120:121], v15 offset:36864
v_cvt_pk_bf16_f32 v179, v186, v187
ds_read_b64_tr_b16 v[122:123], v15 offset:38912
buffer_store_dwordx4 v[176:179], v5, s[16:19], s57 offen offset:2048 sc1
ds_read_b64_tr_b16 v[124:125], v16 offset:36864
v_pk_mul_f32 v[188:189], v[188:189], v[62:63] op_sel_hi:[1,0]
ds_read_b64_tr_b16 v[126:127], v16 offset:38912
v_exp_f32 v70, v188
ds_read_b64_tr_b16 v[128:129], v17 offset:36864
v_exp_f32 v71, v189
ds_read_b64_tr_b16 v[130:131], v17 offset:38912
v_pk_mul_f32 v[190:191], v[190:191], v[62:63] op_sel_hi:[1,0]
v_exp_f32 v74, v190
v_exp_f32 v75, v191
v_pk_fma_f32 v[68:69], v[70:71], -0.5, -1.0 op_sel_hi:[1,0,0]
v_pk_fma_f32 v[68:69], v[70:71], v[68:69], -1.0 op_sel_hi:[1,1,0]
v_rcp_f32 v68, v68
v_rcp_f32 v69, v69
v_pk_fma_f32 v[72:73], v[74:75], -0.5, -1.0 op_sel_hi:[1,0,0]
v_pk_fma_f32 v[72:73], v[74:75], v[72:73], -1.0 op_sel_hi:[1,1,0]
v_rcp_f32 v72, v72
v_rcp_f32 v73, v73
v_pk_fma_f32 v[188:189], v[68:69], v[188:189], v[188:189]
v_pk_fma_f32 v[190:191], v[72:73], v[190:191], v[190:191]
v_cvt_pk_bf16_f32 v188, v188, v189
v_cvt_pk_bf16_f32 v189, v190, v191
v_pk_mul_f32 v[192:193], v[192:193], v[66:67] op_sel_hi:[1,0]
v_exp_f32 v70, v192
v_exp_f32 v71, v193
v_pk_mul_f32 v[194:195], v[194:195], v[66:67] op_sel_hi:[1,0]
v_exp_f32 v74, v194
v_exp_f32 v75, v195
v_pk_fma_f32 v[68:69], v[70:71], -0.5, -1.0 op_sel_hi:[1,0,0]
v_pk_fma_f32 v[68:69], v[70:71], v[68:69], -1.0 op_sel_hi:[1,1,0]
v_rcp_f32 v68, v68
v_rcp_f32 v69, v69
v_pk_fma_f32 v[72:73], v[74:75], -0.5, -1.0 op_sel_hi:[1,0,0]
v_pk_fma_f32 v[72:73], v[74:75], v[72:73], -1.0 op_sel_hi:[1,1,0]
v_rcp_f32 v72, v72
v_rcp_f32 v73, v73
v_pk_fma_f32 v[192:193], v[68:69], v[192:193], v[192:193]
v_pk_fma_f32 v[194:195], v[72:73], v[194:195], v[194:195]
v_cvt_pk_bf16_f32 v190, v192, v193
v_cvt_pk_bf16_f32 v191, v194, v195
buffer_store_dwordx4 v[188:191], v5, s[16:19], s57 offen offset:3072 sc1
s_waitcnt vmcnt(3)
s_mov_b64 exec, 0xff
s_mov_b32 s63, 1000000
v_cmp_eq_u32 vcc, 0, v8
s_cbranch_vccz L_ok3
L_poll3:
buffer_load_dword v2, v51, s[16:19], s97 offen offset:0 sc1
s_waitcnt vmcnt(0)
v_cmp_eq_u32 vcc, 0, v2
s_cbranch_vccz L_ok3
s_sub_u32 s63, s63, 1
s_cbranch_scc0 L_poll3
L_ok3:
s_mov_b64 exec, -1
buffer_load_dwordx4 a[0:3], v34, s[16:19], s64 offen offset:0 sc1
buffer_load_dwordx4 a[4:7], v34, s[16:19], s65 offen offset:0 sc1
buffer_load_dwordx4 a[8:11], v34, s[16:19], s66 offen offset:0 sc1
buffer_load_dwordx4 a[12:15], v34, s[16:19], s67 offen offset:0 sc1
buffer_load_dwordx4 a[16:19], v34, s[16:19], s64 offen offset:1024 sc1
buffer_load_dwordx4 a[20:23], v34, s[16:19], s65 offen offset:1024 sc1
buffer_load_dwordx4 a[24:27], v34, s[16:19], s66 offen offset:1024 sc1
s_waitcnt vmcnt(7)
s_mov_b64 exec, 1
buffer_store_dword v7, off, s[16:19], s58 sc1
s_mov_b64 exec, -1
s_add_u32 s58, s58, 0x20000
buffer_load_dwordx4 a[28:31], v34, s[16:19], s67 offen offset:1024 sc1
buffer_load_dwordx4 a[32:35], v35, s[16:19], s64 offen offset:0 sc1
buffer_load_dwordx4 a[36:39], v35, s[16:19], s65 offen offset:0 sc1
buffer_load_dwordx4 a[40:43], v35, s[16:19], s66 offen offset:0 sc1
buffer_load_dwordx4 a[44:47], v35, s[16:19], s67 offen offset:0 sc1
s_add_u32 s44, s70, 98304
s_add_u32 m0, s48, 4096
s_waitcnt lgkmcnt(0)
buffer_load_dwordx4 v10, s[32:35], s44 offen offset:0 lds
buffer_load_dwordx4 v11, s[32:35], s44 offen offset:1024 lds
s_add_u32 s44, s71, 81920
buffer_load_dwordx4 v12, s[32:35], s44 offen offset:2048 lds
buffer_load_dwordx4 v13, s[32:35], s44 offen offset:3072 lds
s_waitcnt vmcnt(16)
s_waitcnt lgkmcnt(15)
v_mfma_f32_16x16x32_bf16 v[212:215], a[128:131], a[0:3], 0
v_mfma_f32_16x16x32_bf16 v[216:219], a[132:135], a[0:3], 0
buffer_load_dwordx4 a[48:51], v35, s[16:19], s64 offen offset:1024 sc1
v_mfma_f32_16x16x32_bf16 v[220:223], a[136:139], a[0:3], 0
v_mfma_f32_16x16x32_bf16 v[224:227], a[140:143], a[0:3], 0
s_waitcnt vmcnt(16)
v_mfma_f32_16x16x32_bf16 v[212:215], a[144:147], a[4:7], v[212:215]
v_mfma_f32_16x16x32_bf16 v[216:219], a[148:151], a[4:7], v[216:219]
buffer_load_dwordx4 a[52:55], v35, s[16:19], s65 offen offset:1024 sc1
v_mfma_f32_16x16x32_bf16 v[220:223], a[152:155], a[4:7], v[220:223]
v_mfma_f32_16x16x32_bf16 v[224:227], a[156:159], a[4:7], v[224:227]
s_waitcnt vmcnt(16)
v_mfma_f32_16x16x32_bf16 v[212:215], a[160:163], a[8:11], v[212:215]
v_mfma_f32_16x16x32_bf16 v[216:219], a[164:167], a[8:11], v[216:219]
buffer_load_dwordx4 a[56:59], v35, s[16:19], s66 offen offset:1024 sc1
v_mfma_f32_16x16x32_bf16 v[220:223], a[168:171], a[8:11], v[220:223]
v_mfma_f32_16x16x32_bf16 v[224:227], a[172:175], a[8:11], v[224:227]
s_waitcnt vmcnt(16)
v_mfma_f32_16x16x32_bf16 v[212:215], a[176:179], a[12:15], v[212:215]
v_mfma_f32_16x16x32_bf16 v[216:219], a[180:183], a[12:15], v[216:219]
buffer_load_dwordx4 a[60:63], v35, s[16:19], s67 offen offset:1024 sc1
v_mfma_f32_16x16x32_bf16 v[220:223], a[184:187], a[12:15], v[220:223]
v_mfma_f32_16x16x32_bf16 v[224:227], a[188:191], a[12:15], v[224:227]
s_waitcnt vmcnt(16)
v_mfma_f32_16x16x32_bf16 v[212:215], a[192:195], a[16:19], v[212:215]
v_mfma_f32_16x16x32_bf16 v[216:219], a[196:199], a[16:19], v[216:219]
buffer_load_dwordx4 a[64:67], v33, s[16:19], s64 offen offset:0 sc1
v_mfma_f32_16x16x32_bf16 v[220:223], a[200:203], a[16:19], v[220:223]
v_mfma_f32_16x16x32_bf16 v[224:227], a[204:207], a[16:19], v[224:227]
s_waitcnt vmcnt(16)
v_mfma_f32_16x16x32_bf16 v[212:215], a[208:211], a[20:23], v[212:215]
v_mfma_f32_16x16x32_bf16 v[216:219], a[212:215], a[20:23], v[216:219]
buffer_load_dwordx4 a[68:71], v33, s[16:19], s65 offen offset:0 sc1
v_mfma_f32_16x16x32_bf16 v[220:223], a[216:219], a[20:23], v[220:223]
v_mfma_f32_16x16x32_bf16 v[224:227], a[220:223], a[20:23], v[224:227]
s_waitcnt vmcnt(16)
v_mfma_f32_16x16x32_bf16 v[212:215], a[224:227], a[24:27], v[212:215]
v_mfma_f32_16x16x32_bf16 v[216:219], a[228:231], a[24:27], v[216:219]
buffer_load_dwordx4 a[72:75], v33, s[16:19], s66 offen offset:0 sc1
v_mfma_f32_16x16x32_bf16 v[220:223], a[232:235], a[24:27], v[220:223]
v_mfma_f32_16x16x32_bf16 v[224:227], a[236:239], a[24:27], v[224:227]
s_waitcnt vmcnt(15)
v_mfma_f32_16x16x32_bf16 v[212:215], a[240:243], a[28:31], v[212:215]
v_mfma_f32_16x16x32_bf16 v[216:219], a[244:247], a[28:31], v[216:219]
buffer_load_dwordx4 a[76:79], v33, s[16:19], s67 offen offset:0 sc1
v_mfma_f32_16x16x32_bf16 v[220:223], a[248:251], a[28:31], v[220:223]
v_mfma_f32_16x16x32_bf16 v[224:227], a[252:255], a[28:31], v[224:227]
s_waitcnt vmcnt(15)
v_mfma_f32_16x16x32_bf16 v[228:231], a[128:131], a[32:35], 0
v_mfma_f32_16x16x32_bf16 v[232:235], a[132:135], a[32:35], 0
buffer_load_dwordx4 a[80:83], v33, s[16:19], s64 offen offset:1024 sc1
v_mfma_f32_16x16x32_bf16 v[236:239], a[136:139], a[32:35], 0
v_mfma_f32_16x16x32_bf16 v[240:243], a[140:143], a[32:35], 0
s_waitcnt vmcnt(15)
v_mfma_f32_16x16x32_bf16 v[228:231], a[144:147], a[36:39], v[228:231]
v_mfma_f32_16x16x32_bf16 v[232:235], a[148:151], a[36:39], v[232:235]
buffer_load_dwordx4 a[84:87], v33, s[16:19], s65 offen offset:1024 sc1
v_mfma_f32_16x16x32_bf16 v[236:239], a[152:155], a[36:39], v[236:239]
v_mfma_f32_16x16x32_bf16 v[240:243], a[156:159], a[36:39], v[240:243]
s_waitcnt vmcnt(15)
v_mfma_f32_16x16x32_bf16 v[228:231], a[160:163], a[40:43], v[228:231]
v_mfma_f32_16x16x32_bf16 v[232:235], a[164:167], a[40:43], v[232:235]
buffer_load_dwordx4 a[88:91], v33, s[16:19], s66 offen offset:1024 sc1
v_mfma_f32_16x16x32_bf16 v[236:239], a[168:171], a[40:43], v[236:239]
v_mfma_f32_16x16x32_bf16 v[240:243], a[172:175], a[40:43], v[240:243]
s_waitcnt vmcnt(15)
v_mfma_f32_16x16x32_bf16 v[228:231], a[176:179], a[44:47], v[228:231]
v_mfma_f32_16x16x32_bf16 v[232:235], a[180:183], a[44:47], v[232:235]
buffer_load_dwordx4 a[92:95], v33, s[16:19], s67 offen offset:1024 sc1
v_mfma_f32_16x16x32_bf16 v[236:239], a[184:187], a[44:47], v[236:239]
v_mfma_f32_16x16x32_bf16 v[240:243], a[188:191], a[44:47], v[240:243]
s_waitcnt vmcnt(11)
v_mfma_f32_16x16x32_bf16 v[228:231], a[192:195], a[48:51], v[228:231]
v_mfma_f32_16x16x32_bf16 v[232:235], a[196:199], a[48:51], v[232:235]
buffer_load_dwordx4 a[96:99], v32, s[16:19], s64 offen offset:0 sc1
s_mov_b64 exec, 0xff00
buffer_load_dword v8, v51, s[16:19], s97 offen offset:0 sc1
s_mov_b64 exec, -1
v_mfma_f32_16x16x32_bf16 v[236:239], a[200:203], a[48:51], v[236:239]
v_mfma_f32_16x16x32_bf16 v[240:243], a[204:207], a[48:51], v[240:243]
s_waitcnt vmcnt(12)
v_mfma_f32_16x16x32_bf16 v[228:231], a[208:211], a[52:55], v[228:231]
v_mfma_f32_16x16x32_bf16 v[232:235], a[212:215], a[52:55], v[232:235]
buffer_load_dwordx4 a[100:103], v32, s[16:19], s65 offen offset:0 sc1
v_mfma_f32_16x16x32_bf16 v[236:239], a[216:219], a[52:55], v[236:239]
v_mfma_f32_16x16x32_bf16 v[240:243], a[220:223], a[52:55], v[240:243]
s_waitcnt vmcnt(12)
v_mfma_f32_16x16x32_bf16 v[228:231], a[224:227], a[56:59], v[228:231]
v_mfma_f32_16x16x32_bf16 v[232:235], a[228:231], a[56:59], v[232:235]
buffer_load_dwordx4 a[104:107], v32, s[16:19], s66 offen offset:0 sc1
v_mfma_f32_16x16x32_bf16 v[236:239], a[232:235], a[56:59], v[236:239]
v_mfma_f32_16x16x32_bf16 v[240:243], a[236:239], a[56:59], v[240:243]
s_waitcnt vmcnt(41)
ds_read_b64_tr_b16 v[140:141], v56 offset:0
ds_read_b64_tr_b16 v[142:143], v56 offset:2048
s_waitcnt vmcnt(12)
v_mfma_f32_16x16x32_bf16 v[228:231], a[240:243], a[60:63], v[228:231]
ds_read_b64_tr_b16 v[144:145], v57 offset:0
ds_read_b64_tr_b16 v[146:147], v57 offset:2048
v_mfma_f32_16x16x32_bf16 v[232:235], a[244:247], a[60:63], v[232:235]
buffer_load_dwordx4 a[108:111], v32, s[16:19], s67 offen offset:0 sc1
v_mfma_f32_16x16x32_bf16 v[236:239], a[248:251], a[60:63], v[236:239]
ds_read_b64_tr_b16 v[148:149], v58 offset:0
ds_read_b64_tr_b16 v[150:151], v58 offset:2048
v_mfma_f32_16x16x32_bf16 v[240:243], a[252:255], a[60:63], v[240:243]
ds_read_b64_tr_b16 v[152:153], v59 offset:0
ds_read_b64_tr_b16 v[154:155], v59 offset:2048
s_waitcnt vmcnt(12)
v_mfma_f32_16x16x32_bf16 v[196:199], a[128:131], a[64:67], 0
s_waitcnt vmcnt(36)
ds_read_b64_tr_b16 v[156:157], v14 offset:32768
ds_read_b64_tr_b16 v[158:159], v14 offset:34816
v_mfma_f32_16x16x32_bf16 v[200:203], a[132:135], a[64:67], 0
buffer_load_dwordx4 a[112:115], v32, s[16:19], s64 offen offset:1024 sc1
v_mfma_f32_16x16x32_bf16 v[204:207], a[136:139], a[64:67], 0
ds_read_b64_tr_b16 v[160:161], v15 offset:32768
ds_read_b64_tr_b16 v[162:163], v15 offset:34816
v_mfma_f32_16x16x32_bf16 v[208:211], a[140:143], a[64:67], 0
ds_read_b64_tr_b16 v[164:165], v16 offset:32768
ds_read_b64_tr_b16 v[166:167], v16 offset:34816
s_waitcnt vmcnt(12)
v_mfma_f32_16x16x32_bf16 v[196:199], a[144:147], a[68:71], v[196:199]
ds_read_b64_tr_b16 v[168:169], v17 offset:32768
ds_read_b64_tr_b16 v[170:171], v17 offset:34816
v_mfma_f32_16x16x32_bf16 v[200:203], a[148:151], a[68:71], v[200:203]
buffer_load_dwordx4 a[116:119], v32, s[16:19], s65 offen offset:1024 sc1
v_mfma_f32_16x16x32_bf16 v[204:207], a[152:155], a[68:71], v[204:207]
s_waitcnt vmcnt(19)
ds_read_b64_tr_b16 v[132:133], v14 offset:36864
ds_read_b64_tr_b16 v[134:135], v14 offset:38912
v_mfma_f32_16x16x32_bf16 v[208:211], a[156:159], a[68:71], v[208:211]
ds_read_b64_tr_b16 v[136:137], v15 offset:36864
ds_read_b64_tr_b16 v[138:139], v15 offset:38912
s_waitcnt vmcnt(12)
v_mfma_f32_16x16x32_bf16 v[196:199], a[160:163], a[72:75], v[196:199]
ds_read_b64_tr_b16 v[244:245], v16 offset:36864
ds_read_b64_tr_b16 v[246:247], v16 offset:38912
v_mfma_f32_16x16x32_bf16 v[200:203], a[164:167], a[72:75], v[200:203]
buffer_load_dwordx4 a[120:123], v32, s[16:19], s66 offen offset:1024 sc1
v_mfma_f32_16x16x32_bf16 v[204:207], a[168:171], a[72:75], v[204:207]
ds_read_b64_tr_b16 v[248:249], v17 offset:36864
ds_read_b64_tr_b16 v[250:251], v17 offset:38912
v_mfma_f32_16x16x32_bf16 v[208:211], a[172:175], a[72:75], v[208:211]
s_waitcnt vmcnt(12)
v_mfma_f32_16x16x32_bf16 v[196:199], a[176:179], a[76:79], v[196:199]
v_mfma_f32_16x16x32_bf16 v[200:203], a[180:183], a[76:79], v[200:203]
buffer_load_dwordx4 a[124:127], v32, s[16:19], s67 offen offset:1024 sc1
v_mfma_f32_16x16x32_bf16 v[204:207], a[184:187], a[76:79], v[204:207]
v_mfma_f32_16x16x32_bf16 v[208:211], a[188:191], a[76:79], v[208:211]
s_waitcnt vmcnt(12)
v_mfma_f32_16x16x32_bf16 v[196:199], a[192:195], a[80:83], v[196:199]
v_mfma_f32_16x16x32_bf16 v[200:203], a[196:199], a[80:83], v[200:203]
v_mfma_f32_16x16x32_bf16 v[204:207], a[200:203], a[80:83], v[204:207]
v_mfma_f32_16x16x32_bf16 v[208:211], a[204:207], a[80:83], v[208:211]
s_waitcnt vmcnt(11)
v_mfma_f32_16x16x32_bf16 v[196:199], a[208:211], a[84:87], v[196:199]
v_mfma_f32_16x16x32_bf16 v[200:203], a[212:215], a[84:87], v[200:203]
s_waitcnt vmcnt(7)
s_mov_b64 exec, 0xff00
s_mov_b32 s63, 1000000
v_cmp_eq_u32 vcc, 0, v8
s_cbranch_vccz L_ok4
L_poll4:
buffer_load_dword v2, v51, s[16:19], s97 offen offset:0 sc1
s_waitcnt vmcnt(0)
v_cmp_eq_u32 vcc, 0, v2
s_cbranch_vccz L_ok4
s_sub_u32 s63, s63, 1
s_cbranch_scc0 L_poll4
L_ok4:
s_mov_b64 exec, -1
v_mfma_f32_16x16x32_bf16 v[204:207], a[216:219], a[84:87], v[204:207]
buffer_load_dwordx4 a[0:3], v34, s[16:19], s64 offen offset:2048 sc1
v_mfma_f32_16x16x32_bf16 v[208:211], a[220:223], a[84:87], v[208:211]
buffer_load_dwordx4 a[4:7], v34, s[16:19], s65 offen offset:2048 sc1
s_waitcnt vmcnt(12)
v_mfma_f32_16x16x32_bf16 v[196:199], a[224:227], a[88:91], v[196:199]
buffer_load_dwordx4 a[8:11], v34, s[16:19], s66 offen offset:2048 sc1
v_mfma_f32_16x16x32_bf16 v[200:203], a[228:231], a[88:91], v[200:203]
buffer_load_dwordx4 a[12:15], v34, s[16:19], s67 offen offset:2048 sc1
v_mfma_f32_16x16x32_bf16 v[204:207], a[232:235], a[88:91], v[204:207]
buffer_load_dwordx4 v[180:183], v37, s[16:19], s59 offen sc1
v_mfma_f32_16x16x32_bf16 v[208:211], a[236:239], a[88:91], v[208:211]
buffer_load_dwordx4 v[184:187], v37, s[16:19], s60 offen sc1
s_waitcnt vmcnt(15)
v_mfma_f32_16x16x32_bf16 v[196:199], a[240:243], a[92:95], v[196:199]
buffer_load_dwordx4 v[76:79], v37, s[16:19], s61 offen sc1
v_mfma_f32_16x16x32_bf16 v[200:203], a[244:247], a[92:95], v[200:203]
v_mfma_f32_16x16x32_bf16 v[204:207], a[248:251], a[92:95], v[204:207]
v_mfma_f32_16x16x32_bf16 v[208:211], a[252:255], a[92:95], v[208:211]
s_waitcnt vmcnt(15)
v_mfma_f32_16x16x32_bf16 v[60:63], a[128:131], a[96:99], 0
buffer_load_dwordx4 v[80:83], v37, s[16:19], s62 offen sc1
v_mfma_f32_16x16x32_bf16 v[64:67], a[132:135], a[96:99], 0
v_mfma_f32_16x16x32_bf16 v[68:71], a[136:139], a[96:99], 0
v_mfma_f32_16x16x32_bf16 v[72:75], a[140:143], a[96:99], 0
s_waitcnt vmcnt(14)
v_mfma_f32_16x16x32_bf16 v[60:63], a[144:147], a[100:103], v[60:63]
buffer_load_dwordx4 a[16:19], v35, s[16:19], s64 offen offset:2048 sc1
v_mfma_f32_16x16x32_bf16 v[64:67], a[148:151], a[100:103], v[64:67]
v_mfma_f32_16x16x32_bf16 v[68:71], a[152:155], a[100:103], v[68:71]
v_mfma_f32_16x16x32_bf16 v[72:75], a[156:159], a[100:103], v[72:75]
s_waitcnt vmcnt(14)
v_mfma_f32_16x16x32_bf16 v[60:63], a[160:163], a[104:107], v[60:63]
buffer_load_dwordx4 a[20:23], v35, s[16:19], s65 offen offset:2048 sc1
v_mfma_f32_16x16x32_bf16 v[64:67], a[164:167], a[104:107], v[64:67]
v_mfma_f32_16x16x32_bf16 v[68:71], a[168:171], a[104:107], v[68:71]
v_mfma_f32_16x16x32_bf16 v[72:75], a[172:175], a[104:107], v[72:75]
s_waitcnt vmcnt(14)
v_mfma_f32_16x16x32_bf16 v[60:63], a[176:179], a[108:111], v[60:63]
buffer_load_dwordx4 a[24:27], v35, s[16:19], s66 offen offset:2048 sc1
v_mfma_f32_16x16x32_bf16 v[64:67], a[180:183], a[108:111], v[64:67]
v_mfma_f32_16x16x32_bf16 v[68:71], a[184:187], a[108:111], v[68:71]
v_mfma_f32_16x16x32_bf16 v[72:75], a[188:191], a[108:111], v[72:75]
s_waitcnt vmcnt(14)
v_mfma_f32_16x16x32_bf16 v[60:63], a[192:195], a[112:115], v[60:63]
buffer_load_dwordx4 a[28:31], v35, s[16:19], s67 offen offset:2048 sc1
v_mfma_f32_16x16x32_bf16 v[64:67], a[196:199], a[112:115], v[64:67]
v_mfma_f32_16x16x32_bf16 v[68:71], a[200:203], a[112:115], v[68:71]
v_mfma_f32_16x16x32_bf16 v[72:75], a[204:207], a[112:115], v[72:75]
s_waitcnt vmcnt(14)
v_mfma_f32_16x16x32_bf16 v[60:63], a[208:211], a[116:119], v[60:63]
buffer_load_dwordx4 a[32:35], v33, s[16:19], s64 offen offset:2048 sc1
v_mfma_f32_16x16x32_bf16 v[64:67], a[212:215], a[116:119], v[64:67]
v_mfma_f32_16x16x32_bf16 v[68:71], a[216:219], a[116:119], v[68:71]
v_mfma_f32_16x16x32_bf16 v[72:75], a[220:223], a[116:119], v[72:75]
s_waitcnt vmcnt(14)
v_mfma_f32_16x16x32_bf16 v[60:63], a[224:227], a[120:123], v[60:63]
buffer_load_dwordx4 a[36:39], v33, s[16:19], s65 offen offset:2048 sc1
v_mfma_f32_16x16x32_bf16 v[64:67], a[228:231], a[120:123], v[64:67]
v_mfma_f32_16x16x32_bf16 v[68:71], a[232:235], a[120:123], v[68:71]
v_mfma_f32_16x16x32_bf16 v[72:75], a[236:239], a[120:123], v[72:75]
s_waitcnt vmcnt(14)
v_mfma_f32_16x16x32_bf16 v[60:63], a[240:243], a[124:127], v[60:63]
buffer_load_dwordx4 a[40:43], v33, s[16:19], s66 offen offset:2048 sc1
v_mfma_f32_16x16x32_bf16 v[64:67], a[244:247], a[124:127], v[64:67]
v_mfma_f32_16x16x32_bf16 v[68:71], a[248:251], a[124:127], v[68:71]
v_mfma_f32_16x16x32_bf16 v[72:75], a[252:255], a[124:127], v[72:75]
s_waitcnt vmcnt(14)
s_waitcnt lgkmcnt(15)
v_mfma_f32_16x16x32_bf16 v[212:215], v[84:87], a[0:3], v[212:215]
buffer_load_dwordx4 a[44:47], v33, s[16:19], s67 offen offset:2048 sc1
v_mfma_f32_16x16x32_bf16 v[216:219], v[88:91], a[0:3], v[216:219]
v_mfma_f32_16x16x32_bf16 v[220:223], v[92:95], a[0:3], v[220:223]
v_mfma_f32_16x16x32_bf16 v[224:227], v[96:99], a[0:3], v[224:227]
s_waitcnt vmcnt(14)
s_waitcnt lgkmcnt(15)
v_mfma_f32_16x16x32_bf16 v[212:215], v[100:103], a[4:7], v[212:215]
buffer_load_dwordx4 v[172:175], v36, s[16:19], s59 offen sc1
v_mfma_f32_16x16x32_bf16 v[216:219], v[104:107], a[4:7], v[216:219]
v_mfma_f32_16x16x32_bf16 v[220:223], v[108:111], a[4:7], v[220:223]
v_mfma_f32_16x16x32_bf16 v[224:227], v[112:115], a[4:7], v[224:227]
s_waitcnt vmcnt(14)
s_waitcnt lgkmcnt(15)
v_mfma_f32_16x16x32_bf16 v[212:215], v[116:119], a[8:11], v[212:215]
buffer_load_dwordx4 v[176:179], v36, s[16:19], s60 offen sc1
v_mfma_f32_16x16x32_bf16 v[216:219], v[120:123], a[8:11], v[216:219]
v_mfma_f32_16x16x32_bf16 v[220:223], v[124:127], a[8:11], v[220:223]
v_mfma_f32_16x16x32_bf16 v[224:227], v[128:131], a[8:11], v[224:227]
s_waitcnt vmcnt(14)
s_waitcnt lgkmcnt(15)
v_mfma_f32_16x16x32_bf16 v[212:215], v[140:143], a[12:15], v[212:215]
buffer_load_dwordx4 v[188:191], v36, s[16:19], s61 offen sc1
v_mfma_f32_16x16x32_bf16 v[216:219], v[144:147], a[12:15], v[216:219]
v_mfma_f32_16x16x32_bf16 v[220:223], v[148:151], a[12:15], v[220:223]
v_mfma_f32_16x16x32_bf16 v[224:227], v[152:155], a[12:15], v[224:227]
s_waitcnt vmcnt(13)
s_waitcnt lgkmcnt(8)
s_bitcmp1_b32 s1, 0
s_cbranch_scc1 L_odd0_1
v_swap_b32 v182, v184
v_swap_b32 v183, v185
s_branch L_sw0_1
L_odd0_1:
v_swap_b32 v180, v186
v_swap_b32 v181, v187
L_sw0_1:
s_nop 1
v_mfma_f32_16x16x32_bf16 v[212:215], v[156:159], v[180:183], v[212:215]
buffer_load_dwordx4 v[192:195], v36, s[16:19], s62 offen sc1
v_mfma_f32_16x16x32_bf16 v[216:219], v[160:163], v[180:183], v[216:219]
v_mfma_f32_16x16x32_bf16 v[220:223], v[164:167], v[180:183], v[220:223]
v_mfma_f32_16x16x32_bf16 v[224:227], v[168:171], v[180:183], v[224:227]
s_waitcnt vmcnt(12)
s_waitcnt lgkmcnt(0)
s_bitcmp1_b32 s1, 0
s_cbranch_scc1 L_odd1_1
v_swap_b32 v78, v80
v_swap_b32 v79, v81
s_branch L_sw1_1
L_odd1_1:
v_swap_b32 v76, v82
v_swap_b32 v77, v83
L_sw1_1:
s_nop 1
v_mfma_f32_16x16x32_bf16 v[212:215], v[132:135], v[76:79], v[212:215]
buffer_load_dwordx4 a[48:51], v32, s[16:19], s64 offen offset:2048 sc1
v_mfma_f32_16x16x32_bf16 v[216:219], v[136:139], v[76:79], v[216:219]
v_mfma_f32_16x16x32_bf16 v[220:223], v[244:247], v[76:79], v[220:223]
v_mfma_f32_16x16x32_bf16 v[224:227], v[248:251], v[76:79], v[224:227]
s_waitcnt vmcnt(12)
v_mfma_f32_16x16x32_bf16 v[228:231], v[84:87], a[16:19], v[228:231]
buffer_load_dwordx4 a[52:55], v32, s[16:19], s65 offen offset:2048 sc1
v_mfma_f32_16x16x32_bf16 v[232:235], v[88:91], a[16:19], v[232:235]
v_mfma_f32_16x16x32_bf16 v[236:239], v[92:95], a[16:19], v[236:239]
ds_write_b128 v46, v[212:215] offset:4096
v_mfma_f32_16x16x32_bf16 v[240:243], v[96:99], a[16:19], v[240:243]
s_waitcnt vmcnt(12)
v_mfma_f32_16x16x32_bf16 v[228:231], v[100:103], a[20:23], v[228:231]
buffer_load_dwordx4 a[56:59], v32, s[16:19], s66 offen offset:2048 sc1
v_mfma_f32_16x16x32_bf16 v[232:235], v[104:107], a[20:23], v[232:235]
v_mfma_f32_16x16x32_bf16 v[236:239], v[108:111], a[20:23], v[236:239]
ds_write_b128 v46, v[216:219] offset:5120
v_mfma_f32_16x16x32_bf16 v[240:243], v[112:115], a[20:23], v[240:243]
s_waitcnt vmcnt(12)
v_mfma_f32_16x16x32_bf16 v[228:231], v[116:119], a[24:27], v[228:231]
buffer_load_dwordx4 a[60:63], v32, s[16:19], s67 offen offset:2048 sc1
v_mfma_f32_16x16x32_bf16 v[232:235], v[120:123], a[24:27], v[232:235]
v_mfma_f32_16x16x32_bf16 v[236:239], v[124:127], a[24:27], v[236:239]
ds_write_b128 v46, v[220:223] offset:6144
v_mfma_f32_16x16x32_bf16 v[240:243], v[128:131], a[24:27], v[240:243]
s_waitcnt vmcnt(12)
v_mfma_f32_16x16x32_bf16 v[228:231], v[140:143], a[28:31], v[228:231]
v_mfma_f32_16x16x32_bf16 v[232:235], v[144:147], a[28:31], v[232:235]
v_mfma_f32_16x16x32_bf16 v[236:239], v[148:151], a[28:31], v[236:239]
ds_write_b128 v46, v[224:227] offset:7168
v_mfma_f32_16x16x32_bf16 v[240:243], v[152:155], a[28:31], v[240:243]
v_mfma_f32_16x16x32_bf16 v[228:231], v[156:159], v[184:187], v[228:231]
v_mfma_f32_16x16x32_bf16 v[232:235], v[160:163], v[184:187], v[232:235]
v_mfma_f32_16x16x32_bf16 v[236:239], v[164:167], v[184:187], v[236:239]
v_mfma_f32_16x16x32_bf16 v[240:243], v[168:171], v[184:187], v[240:243]
v_mfma_f32_16x16x32_bf16 v[228:231], v[132:135], v[80:83], v[228:231]
v_mfma_f32_16x16x32_bf16 v[232:235], v[136:139], v[80:83], v[232:235]
v_mfma_f32_16x16x32_bf16 v[236:239], v[244:247], v[80:83], v[236:239]
v_mfma_f32_16x16x32_bf16 v[240:243], v[248:251], v[80:83], v[240:243]
s_waitcnt vmcnt(11)
v_mfma_f32_16x16x32_bf16 v[196:199], v[84:87], a[32:35], v[196:199]
v_mfma_f32_16x16x32_bf16 v[200:203], v[88:91], a[32:35], v[200:203]
v_mov_b32 v3, 0x3f317218
v_lshlrev_b32 v180, 16, v20
v_mfma_f32_16x16x32_bf16 v[204:207], v[92:95], a[32:35], v[204:207]
ds_write_b128 v47, v[228:231] offset:0
v_mfma_f32_16x16x32_bf16 v[208:211], v[96:99], a[32:35], v[208:211]
v_and_b32 v181, 0xffff0000, v20
v_lshlrev_b32 v182, 16, v21
s_waitcnt vmcnt(10)
v_mfma_f32_16x16x32_bf16 v[196:199], v[100:103], a[36:39], v[196:199]
v_and_b32 v183, 0xffff0000, v21
v_lshlrev_b32 v184, 16, v22
v_mfma_f32_16x16x32_bf16 v[200:203], v[104:107], a[36:39], v[200:203]
v_and_b32 v185, 0xffff0000, v22
v_lshlrev_b32 v186, 16, v23
v_mfma_f32_16x16x32_bf16 v[204:207], v[108:111], a[36:39], v[204:207]
ds_write_b128 v47, v[232:235] offset:1024
v_mfma_f32_16x16x32_bf16 v[208:211], v[112:115], a[36:39], v[208:211]
v_and_b32 v187, 0xffff0000, v23
v_lshlrev_b32 v76, 16, v24
s_waitcnt vmcnt(9)
v_mfma_f32_16x16x32_bf16 v[196:199], v[116:119], a[40:43], v[196:199]
v_and_b32 v77, 0xffff0000, v24
v_lshlrev_b32 v78, 16, v25
v_mfma_f32_16x16x32_bf16 v[200:203], v[120:123], a[40:43], v[200:203]
v_and_b32 v79, 0xffff0000, v25
v_lshlrev_b32 v80, 16, v26
v_mfma_f32_16x16x32_bf16 v[204:207], v[124:127], a[40:43], v[204:207]
ds_write_b128 v47, v[236:239] offset:2048
v_mfma_f32_16x16x32_bf16 v[208:211], v[128:131], a[40:43], v[208:211]
v_and_b32 v81, 0xffff0000, v26
v_lshlrev_b32 v82, 16, v27
s_waitcnt vmcnt(8)
v_mfma_f32_16x16x32_bf16 v[196:199], v[140:143], a[44:47], v[196:199]
v_and_b32 v83, 0xffff0000, v27
v_mfma_f32_16x16x32_bf16 v[200:203], v[144:147], a[44:47], v[200:203]
v_mfma_f32_16x16x32_bf16 v[204:207], v[148:151], a[44:47], v[204:207]
ds_write_b128 v47, v[240:243] offset:3072
v_mfma_f32_16x16x32_bf16 v[208:211], v[152:155], a[44:47], v[208:211]
s_waitcnt vmcnt(6)
s_bitcmp1_b32 s1, 0
s_cbranch_scc1 L_odd0_0
v_swap_b32 v174, v176
v_swap_b32 v175, v177
s_branch L_sw0_0
L_odd0_0:
v_swap_b32 v172, v178
v_swap_b32 v173, v179
L_sw0_0:
s_nop 1
v_mfma_f32_16x16x32_bf16 v[196:199], v[156:159], v[176:179], v[196:199]
v_mfma_f32_16x16x32_bf16 v[200:203], v[160:163], v[176:179], v[200:203]
v_mfma_f32_16x16x32_bf16 v[204:207], v[164:167], v[176:179], v[204:207]
v_mfma_f32_16x16x32_bf16 v[208:211], v[168:171], v[176:179], v[208:211]
s_waitcnt vmcnt(4)
s_bitcmp1_b32 s1, 0
s_cbranch_scc1 L_odd1_0
v_swap_b32 v190, v192
v_swap_b32 v191, v193
s_branch L_sw1_0
L_odd1_0:
v_swap_b32 v188, v194
v_swap_b32 v189, v195
L_sw1_0:
s_nop 1
v_mfma_f32_16x16x32_bf16 v[196:199], v[132:135], v[192:195], v[196:199]
v_mfma_f32_16x16x32_bf16 v[200:203], v[136:139], v[192:195], v[200:203]
v_mfma_f32_16x16x32_bf16 v[204:207], v[244:247], v[192:195], v[204:207]
v_mfma_f32_16x16x32_bf16 v[208:211], v[248:251], v[192:195], v[208:211]
s_waitcnt vmcnt(3)
v_mfma_f32_16x16x32_bf16 v[60:63], v[84:87], a[48:51], v[60:63]
v_mfma_f32_16x16x32_bf16 v[64:67], v[88:91], a[48:51], v[64:67]
v_mfma_f32_16x16x32_bf16 v[68:71], v[92:95], a[48:51], v[68:71]
s_nop 0
ds_write_b128 v46, v[196:199] offset:0
v_mfma_f32_16x16x32_bf16 v[72:75], v[96:99], a[48:51], v[72:75]
s_waitcnt vmcnt(2)
v_mfma_f32_16x16x32_bf16 v[60:63], v[100:103], a[52:55], v[60:63]
v_mfma_f32_16x16x32_bf16 v[64:67], v[104:107], a[52:55], v[64:67]
v_mfma_f32_16x16x32_bf16 v[68:71], v[108:111], a[52:55], v[68:71]
ds_write_b128 v46, v[200:203] offset:1024
v_mfma_f32_16x16x32_bf16 v[72:75], v[112:115], a[52:55], v[72:75]
s_waitcnt vmcnt(1)
v_mfma_f32_16x16x32_bf16 v[60:63], v[116:119], a[56:59], v[60:63]
v_mfma_f32_16x16x32_bf16 v[64:67], v[120:123], a[56:59], v[64:67]
v_mfma_f32_16x16x32_bf16 v[68:71], v[124:127], a[56:59], v[68:71]
ds_write_b128 v46, v[204:207] offset:2048
v_mfma_f32_16x16x32_bf16 v[72:75], v[128:131], a[56:59], v[72:75]
s_waitcnt vmcnt(0)
v_mfma_f32_16x16x32_bf16 v[60:63], v[140:143], a[60:63], v[60:63]
v_mfma_f32_16x16x32_bf16 v[64:67], v[144:147], a[60:63], v[64:67]
v_mfma_f32_16x16x32_bf16 v[68:71], v[148:151], a[60:63], v[68:71]
ds_write_b128 v46, v[208:211] offset:3072
v_mfma_f32_16x16x32_bf16 v[72:75], v[152:155], a[60:63], v[72:75]
v_mfma_f32_16x16x32_bf16 v[60:63], v[156:159], v[172:175], v[60:63]
v_mfma_f32_16x16x32_bf16 v[64:67], v[160:163], v[172:175], v[64:67]
s_waitcnt lgkmcnt(0)
s_barrier
ds_read_b128 v[196:199], v48 offset:0
ds_read_b128 v[200:203], v48 offset:1024
v_mfma_f32_16x16x32_bf16 v[68:71], v[164:167], v[172:175], v[68:71]
ds_read_b128 v[204:207], v48 offset:2048
ds_read_b128 v[208:211], v48 offset:3072
ds_read_b128 v[212:215], v49 offset:4096
v_mfma_f32_16x16x32_bf16 v[72:75], v[168:171], v[172:175], v[72:75]
ds_read_b128 v[216:219], v49 offset:5120
ds_read_b128 v[220:223], v49 offset:6144
ds_read_b128 v[224:227], v49 offset:7168
v_mfma_f32_16x16x32_bf16 v[60:63], v[132:135], v[188:191], v[60:63]
ds_read_b128 v[228:231], v50 offset:0
ds_read_b128 v[232:235], v50 offset:1024
ds_read_b128 v[236:239], v50 offset:2048
v_mfma_f32_16x16x32_bf16 v[64:67], v[136:139], v[188:191], v[64:67]
ds_read_b128 v[240:243], v50 offset:3072
v_mfma_f32_16x16x32_bf16 v[68:71], v[244:247], v[188:191], v[68:71]
v_mfma_f32_16x16x32_bf16 v[72:75], v[248:251], v[188:191], v[72:75]
s_waitcnt lgkmcnt(8)
v_fmac_f32 v180, v196, v3
v_fmac_f32 v181, v197, v3
v_fmac_f32 v182, v198, v3
v_fmac_f32 v183, v199, v3
v_fmac_f32 v184, v200, v3
v_fmac_f32 v185, v201, v3
v_fmac_f32 v186, v202, v3
v_fmac_f32 v187, v203, v3
v_fmac_f32 v76, v204, v3
v_fmac_f32 v77, v205, v3
v_fmac_f32 v78, v206, v3
v_fmac_f32 v79, v207, v3
v_fmac_f32 v80, v208, v3
v_fmac_f32 v81, v209, v3
v_fmac_f32 v82, v210, v3
v_fmac_f32 v83, v211, v3
s_waitcnt lgkmcnt(4)
v_fmac_f32 v180, v212, v3
v_fmac_f32 v181, v213, v3
v_fmac_f32 v182, v214, v3
v_fmac_f32 v183, v215, v3
v_fmac_f32 v184, v216, v3
v_fmac_f32 v185, v217, v3
v_fmac_f32 v186, v218, v3
v_fmac_f32 v187, v219, v3
v_fmac_f32 v76, v220, v3
v_fmac_f32 v77, v221, v3
v_fmac_f32 v78, v222, v3
v_fmac_f32 v79, v223, v3
v_fmac_f32 v80, v224, v3
v_fmac_f32 v81, v225, v3
v_fmac_f32 v82, v226, v3
v_fmac_f32 v83, v227, v3
s_waitcnt lgkmcnt(0)
v_fmac_f32 v180, v228, v3
v_fmac_f32 v181, v229, v3
v_fmac_f32 v182, v230, v3
v_fmac_f32 v183, v231, v3
v_fmac_f32 v184, v232, v3
v_fmac_f32 v185, v233, v3
v_fmac_f32 v186, v234, v3
v_fmac_f32 v187, v235, v3
v_fmac_f32 v76, v236, v3
v_fmac_f32 v77, v237, v3
v_fmac_f32 v78, v238, v3
v_fmac_f32 v79, v239, v3
v_fmac_f32 v80, v240, v3
v_fmac_f32 v81, v241, v3
v_fmac_f32 v82, v242, v3
v_fmac_f32 v83, v243, v3
v_fmac_f32 v180, v60, v3
v_fmac_f32 v181, v61, v3
v_cvt_pk_bf16_f32 v20, v180, v181
v_fmac_f32 v182, v62, v3
v_fmac_f32 v183, v63, v3
v_cvt_pk_bf16_f32 v21, v182, v183
v_fmac_f32 v184, v64, v3
v_fmac_f32 v185, v65, v3
v_cvt_pk_bf16_f32 v22, v184, v185
v_fmac_f32 v186, v66, v3
v_fmac_f32 v187, v67, v3
v_cvt_pk_bf16_f32 v23, v186, v187
v_permlane16_swap_b32 v20, v22
s_nop 0
v_permlane16_swap_b32 v21, v23
buffer_store_dwordx4 v[20:23], v9, s[40:43], s49 offen offset:0
v_fmac_f32 v76, v68, v3
v_fmac_f32 v77, v69, v3
v_cvt_pk_bf16_f32 v24, v76, v77
v_fmac_f32 v78, v70, v3
v_fmac_f32 v79, v71, v3
v_cvt_pk_bf16_f32 v25, v78, v79
v_fmac_f32 v80, v72, v3
v_fmac_f32 v81, v73, v3
v_cvt_pk_bf16_f32 v26, v80, v81
v_fmac_f32 v82, v74, v3
v_fmac_f32 v83, v75, v3
v_cvt_pk_bf16_f32 v27, v82, v83
v_permlane16_swap_b32 v24, v26
s_nop 0
v_permlane16_swap_b32 v25, v27
buffer_store_dwordx4 v[24:27], v9, s[40:43], s49 offen offset:64
L_done:
s_endpgm
L_code_end:
.section .rodata,"a"
.p2align 6
.amdhsa_kernel sequential_preLN__linear_attn_block__dense_activation_mish__prompt_kernel
  .amdhsa_next_free_vgpr 512
  .amdhsa_next_free_sgpr 102
  .amdhsa_accum_offset 256
  .amdhsa_group_segment_fixed_size 0
  .amdhsa_kernarg_size 80
  .amdhsa_user_sgpr_count 2
  .amdhsa_user_sgpr_kernarg_segment_ptr 1
  .amdhsa_system_sgpr_workgroup_id_x 1
.end_amdhsa_kernel
```
